```python
import torch

def _softmax(x, axis=-1):
    return torch.softmax(x, dim=axis)
def _gelu(x):
    return torch.nn.functional.gelu(x, approximate="tanh")
def _silu(x):
    return torch.nn.functional.silu(x)
def _sigmoid(x):
    return torch.sigmoid(x)
def _layernorm(x, axis=-1, eps=1e-5):
    m = x.mean(dim=axis, keepdim=True)
    v = x.var(dim=axis, keepdim=True, unbiased=False)
    return (x - m) / torch.sqrt(v + eps)
def _scatter_add(tgt, idx, src, axis=0):
    return tgt.clone().index_add_(axis, idx, src)
def _segment_sum(src, seg, n):
    out = torch.zeros((n,) + src.shape[1:], dtype=src.dtype)
    return out.index_add_(0, seg, src)
def _pad(x, pw):
    flat = tuple(v for pair in reversed(pw) for v in pair)
    return torch.nn.functional.pad(x, flat)

kernel_name = 'sequential_preLN__spectral_gfnet__mixer_s_mlp__prompt'

def setup_inputs():

    _w = (lambda a: (lambda t: t.to(torch.bfloat16) if t.is_floating_point() else t)(torch.as_tensor(a)))
    def _A_setup():
        B, S, D = 1, 2048, 640
        Df = D // 2 + 1
        return {
            "x": _w((lambda *s: torch.randn(*s, dtype=torch.bfloat16) * 0.05)(B, S, D)),
            "w_r": _w((lambda *s: torch.randn(*s, dtype=torch.bfloat16) * 0.4)(S, Df) * 0.02),
            "w_i": _w((lambda *s: torch.randn(*s, dtype=torch.bfloat16) * 0.4)(S, Df) * 0.02),
        }
    _A_in = _A_setup()

    def _B_setup():
        B, S, D, F = 1, 2048, 640, 1536
        return {
            "x":  _w((lambda *s: torch.randn(*s, dtype=torch.bfloat16) * 0.05)(B, S, D)),
            "w1": _w((lambda *s: torch.randn(*s, dtype=torch.bfloat16) * 0.8)(D, D) * (D ** -0.5)),
            "w2": _w((lambda *s: torch.randn(*s, dtype=torch.bfloat16) * 0.8)(D, D) * (D ** -0.5)),
            "w3": _w((lambda *s: torch.randn(*s, dtype=torch.bfloat16) * 0.8)(D, F) * (D ** -0.5)),
            "w4": _w((lambda *s: torch.randn(*s, dtype=torch.bfloat16) * 0.8)(F, D) * (F ** -0.5)),
        }
    _B_in = _B_setup()

    return {
        "A_x": _A_in["x"],
        "A_w_r": _A_in["w_r"],
        "A_w_i": _A_in["w_i"],
        "B_x": _B_in["x"],
        "B_w1": _B_in["w1"],
        "B_w2": _B_in["w2"],
        "B_w3": _B_in["w3"],
        "B_w4": _B_in["w4"],
    }

def reference(A_x, A_w_r, A_w_i, B_x, B_w1, B_w2, B_w3, B_w4):
    def _A_ref(x, w_r, w_i):
        B, S, D = x.shape
        X = (lambda x, axes=(-2,-1): torch.fft.rfft2(x.float(), dim=axes))(x, axes=(-2, -1))
        W = w_r + 1j * w_i
        X = X * W
        y = (lambda x, s, axes=(-2,-1): torch.fft.irfft2(x, s=s, dim=axes).to(torch.bfloat16))(X, (S, D), axes=(-2, -1))
        return y

    def _B_ref(x, w1, w2, w3, w4):
        B, S, D = x.shape
        h = _gelu(_layernorm(x, axis=-1) @ w1)
        c = D // 4
        g0 = _pad(h[:, :, 0*c:1*c], ((0, 0), (1, 0), (0, 0)))[:, :S, :]
        g1 = _pad(h[:, :, 1*c:2*c], ((0, 0), (0, 1), (0, 0)))[:, 1:, :]
        g2 = _pad(h[:, :, 2*c:3*c], ((0, 0), (2, 0), (0, 0)))[:, :S, :]
        g3 = _pad(h[:, :, 3*c:   ], ((0, 0), (0, 2), (0, 0)))[:, 2:, :]
        hs = torch.concatenate([g0, g1, g2, g3], axis=-1) @ w2
        x1 = x + hs
        h2 = _gelu(_layernorm(x1, axis=-1) @ w3) @ w4
        return x1 + h2

    x = A_x
    h = x + _A_ref(_layernorm(x, axis=-1), A_w_r, A_w_i)
    h2 = h + _B_ref(_layernorm(h, axis=-1), B_w1, B_w2, B_w3, B_w4)
    return h2
```

```asm
; @launch grid=(256,1,1) block=(256,1,1) lds=163840
.amdgcn_target "amdgcn-amd-amdhsa--gfx950"
.text
.globl sequential_preLN__spectral_gfnet__mixer_s_mlp__prompt_kernel
.p2align 8
.type sequential_preLN__spectral_gfnet__mixer_s_mlp__prompt_kernel,@function
sequential_preLN__spectral_gfnet__mixer_s_mlp__prompt_kernel:
  s_cmp_ge_u32 s2, 256
  s_cbranch_scc1 L_end
  s_load_dwordx16 s[48:63], s[0:1], 0
  s_load_dwordx4 s[64:67], s[0:1], 64
  s_load_dwordx2 s[68:69], s[0:1], 80
  s_memrealtime s[70:71]
  s_getpc_b64 s[72:73]
Lpc:
  v_lshrrev_b32 v31, 2, v0
  s_bfe_u32 s74, s2, 0x30003
  s_mul_i32 s74, s74, 5632
  v_lshl_add_u32 v31, v31, 7, s74
  v_min_u32 v16, code_end-Lpc-4, v31
  v_mov_b32 v17, s73
  v_add_co_u32 v16, vcc, s72, v16
  s_nop 1
  v_addc_co_u32 v17, vcc, 0, v17, vcc
  global_load_dword a255, v[16:17], off
  v_readfirstlane_b32 s3, v0
  v_and_b32 v1, 63, v0
  s_lshr_b32 s3, s3, 6
  v_lshlrev_b32 v2, 4, v1
  v_and_b32 v4, 15, v1
  v_lshrrev_b32 v5, 4, v1
  s_mov_b32 s78, 200000
  s_lshr_b32 s74, s2, 3
  s_xor_b32 s74, s74, s2
  s_and_b32 s74, s74, 1
  s_mul_i32 s74, s74, 9
  s_xor_b32 s79, s2, s74
  s_bfe_u32 s45, s2, 0x20001
  s_lshl_b32 s45, s45, 3
  s_bfe_u32 s74, s2, 0x30003
  s_add_u32 s45, s45, s74
  s_and_b32 s46, s2, 1
  s_lshl_b32 s46, s46, 2
  s_lshr_b32 s74, s2, 6
  s_add_u32 s46, s46, s74
  s_and_b32 s74, s2, 31
  s_lshr_b32 s75, s2, 5
  s_lshl_b32 s75, s75, 7
  s_add_u32 s75, s75, s74
  s_lshl_b32 s76, s3, 5
  s_add_u32 s76, s76, s75
  s_mul_i32 s76, s76, 1280
  v_lshrrev_b32 v20, 5, v1
  v_mul_u32_u24 v20, 1310720, v20
  v_and_b32 v21, 31, v1
  v_mad_u32_u24 v20, v21, 40, v20
  s_and_b32 s77, s2, 63
  s_bfe_u32 s74, s2, 0x10006
  s_lshl_b32 s74, s74, 8
  s_add_u32 s77, s77, s74
  s_mul_i32 s77, s77, 642
  s_lshl_b32 s74, s3, 6
  s_add_u32 s77, s77, s74
  s_add_u32 s77, s77, 2
  v_bfe_u32 v21, v1, 2, 2
  v_lshl_add_u32 v21, v5, 3, v21
  v_mul_u32_u24 v21, 41088, v21
  v_and_b32 v22, 3, v1
  v_lshl_add_u32 v21, v22, 4, v21
  v_lshlrev_b32 v29, 4, v0
  s_mov_b32 s6, 2621440
  s_mov_b32 s7, 0x20000
  s_waitcnt lgkmcnt(0)
  s_mov_b32 s4, s48
  s_mov_b32 s5, s49
  buffer_load_dwordx4 v[132:135], v20, s[4:7], s76 offen
  buffer_load_dwordx4 v[136:139], v20, s[4:7], s76 offen offset:16
  buffer_load_dwordx2 v[140:141], v20, s[4:7], s76 offen offset:32
  s_mov_b32 s8, s68
  s_mov_b32 s9, s69
  s_mov_b32 s10, 0x19e8000
  s_mov_b32 s11, 0x20000
  s_mov_b32 s40, s66
  s_mov_b32 s41, s67
  s_mov_b32 s42, 0x100
  s_mov_b32 s43, 0x20000
  s_mov_b32 s20, s56
  s_mov_b32 s21, s57
  s_mov_b32 s22, 0xc8000
  s_mov_b32 s23, 0x20000
  s_mov_b32 s24, s58
  s_mov_b32 s25, s59
  s_mov_b32 s26, 0xc8000
  s_mov_b32 s27, 0x20000
  s_bitcmp1_b32 s2, 7
  s_cselect_b32 s12, s52, s50
  s_cselect_b32 s13, s53, s51
  s_mov_b32 s14, 1314816
  s_mov_b32 s15, 0x20000
  s_mov_b32 s52, s70
  s_or_b32 s53, s2, s3
  s_cmp_lg_u32 s53, 0
  s_cbranch_scc1 Lnotag
  s_or_b32 s53, s70, 0x80000000
  s_and_b32 s53, s53, 0xfffffff0
  v_mov_b32 v16, s53
  s_mov_b64 exec, 1
  buffer_store_dword v16, off, s[40:43], 0 sc1
  s_mov_b64 exec, -1
Lnotag:
  s_mul_i32 s53, s3, 3072
  s_add_u32 m0, s53, 30720
  s_nop 0
  buffer_load_dwordx4 v21, s[12:15], s77 offen lds
  s_addk_i32 m0, 1024
  s_add_u32 s77, s77, 256
  buffer_load_dwordx4 v21, s[12:15], s77 offen lds
  s_addk_i32 m0, 1024
  s_add_u32 s77, s77, 256
  buffer_load_dwordx4 v21, s[12:15], s77 offen lds
  v_mul_u32_u24 v16, 13108, v1
  v_lshrrev_b32 v16, 16, v16
  v_mul_u32_u24 v17, 5, v16
  v_sub_u32 v17, v1, v17
  v_mul_u32_u24 v16, 1280, v16
  v_lshl_add_u32 v31, v17, 7, v16
  v_cmp_gt_u32 vcc, 25, v1
  v_mov_b32 v16, 0x40000000
  s_nop 0
  v_cndmask_b32 v31, v16, v31, vcc
  s_lshr_b32 s53, s2, 3
  s_lshl_b32 s53, s53, 2
  s_add_u32 s53, s53, s3
  s_mul_i32 s53, s53, 6400
  s_and_b32 s54, s2, 1
  s_mul_i32 s54, s54, 640
  s_add_u32 s51, s53, s54
  v_bfe_u32 v26, v1, 3, 2
  v_lshlrev_b32 v26, 2, v26
  v_and_b32 v27, 3, v1
  v_add_u32 v26, v26, v27
  v_bfe_u32 v27, v1, 2, 1
  v_mul_u32_u24 v27, 10, v27
  v_add_u32 v26, v26, v27
  v_cvt_f32_u32 v26, v26
  v_and_b32 v24, 31, v1
  v_lshrrev_b32 v25, 5, v1
  v_cvt_f32_u32 v24, v24
  v_cvt_f32_u32 v25, v25
  v_add_u32 v27, 61440, v2
  s_cmp_eq_u32 s3, 1
  s_nop 0
  s_cbranch_scc1 Lcw1
  s_cmp_eq_u32 s3, 2
  s_cbranch_scc1 Lcw2
  s_cmp_eq_u32 s3, 3
  s_cbranch_scc1 Lcw3
  v_mul_f32 v189, 0x3d4ccccd, v26
  v_mul_f32 v188, 0xbe800000, v25
  v_cos_f32 v190, v188
  v_sin_f32 v192, v188
  v_add_f32 v188, v188, v189
  v_cos_f32 v191, v188
  v_sin_f32 v193, v188
  v_add_f32 v188, v188, v189
  v_cvt_pk_bf16_f32 v44, v190, v191
  v_cvt_pk_bf16_f32 v56, -v192, -v193
  v_cos_f32 v190, v188
  v_sin_f32 v192, v188
  v_add_f32 v188, v188, v189
  v_cos_f32 v191, v188
  v_sin_f32 v193, v188
  v_add_f32 v188, v188, v189
  v_cvt_pk_bf16_f32 v45, v190, v191
  v_cvt_pk_bf16_f32 v57, -v192, -v193
  v_cos_f32 v190, v188
  v_sin_f32 v192, v188
  v_add_f32 v188, v188, v189
  v_cos_f32 v191, v188
  v_sin_f32 v193, v188
  v_add_f32 v188, v188, v189
  v_cvt_pk_bf16_f32 v46, v190, v191
  v_cvt_pk_bf16_f32 v58, -v192, -v193
  v_cos_f32 v190, v188
  v_sin_f32 v192, v188
  v_add_f32 v188, v188, v189
  v_cos_f32 v191, v188
  v_sin_f32 v193, v188
  v_cvt_pk_bf16_f32 v47, v190, v191
  v_cvt_pk_bf16_f32 v59, -v192, -v193
  ds_write_b128 v27, v[44:47] offset:0
  ds_write_b128 v27, v[56:59] offset:1024
  s_branch Lcwj
Lcw1:
  v_mov_b32 v54, 0
  v_mov_b32 v55, 0
  v_mov_b32 v66, 0
  v_mov_b32 v67, 0
  v_mul_f32 v189, 0x3d4ccccd, v26
  v_mul_f32 v188, 0xbe800000, v25
  v_fmac_f32 v188, 0x41000000, v189
  v_cos_f32 v190, v188
  v_sin_f32 v192, v188
  v_add_f32 v188, v188, v189
  v_cos_f32 v191, v188
  v_sin_f32 v193, v188
  v_add_f32 v188, v188, v189
  v_cvt_pk_bf16_f32 v48, v190, v191
  v_cvt_pk_bf16_f32 v60, -v192, -v193
  v_cos_f32 v190, v188
  v_sin_f32 v192, v188
  v_add_f32 v188, v188, v189
  v_cos_f32 v191, v188
  v_sin_f32 v193, v188
  v_add_f32 v188, v188, v189
  v_cvt_pk_bf16_f32 v49, v190, v191
  v_cvt_pk_bf16_f32 v61, -v192, -v193
  v_cos_f32 v190, v188
  v_sin_f32 v192, v188
  v_add_f32 v188, v188, v189
  v_cos_f32 v191, v188
  v_sin_f32 v193, v188
  v_add_f32 v188, v188, v189
  v_cvt_pk_bf16_f32 v50, v190, v191
  v_cvt_pk_bf16_f32 v62, -v192, -v193
  v_cos_f32 v190, v188
  v_sin_f32 v192, v188
  v_add_f32 v188, v188, v189
  v_cos_f32 v191, v188
  v_sin_f32 v193, v188
  v_add_f32 v188, v188, v189
  v_cvt_pk_bf16_f32 v51, v190, v191
  v_cvt_pk_bf16_f32 v63, -v192, -v193
  v_cos_f32 v190, v188
  v_sin_f32 v192, v188
  v_add_f32 v188, v188, v189
  v_cos_f32 v191, v188
  v_sin_f32 v193, v188
  v_add_f32 v188, v188, v189
  v_cvt_pk_bf16_f32 v52, v190, v191
  v_cvt_pk_bf16_f32 v64, -v192, -v193
  v_cos_f32 v190, v188
  v_sin_f32 v192, v188
  v_add_f32 v188, v188, v189
  v_cos_f32 v191, v188
  v_sin_f32 v193, v188
  v_cvt_pk_bf16_f32 v53, v190, v191
  v_cvt_pk_bf16_f32 v65, -v192, -v193
  ds_write_b128 v27, v[48:51] offset:2048
  ds_write_b128 v27, v[60:63] offset:3072
  ds_write_b128 v27, v[52:55] offset:4096
  ds_write_b128 v27, v[64:67] offset:5120
  s_branch Lcwj
Lcw2:
  v_mul_f32 v189, 0x3acccccd, v26
  v_mul_f32 v190, 0x40a00000, v189
  v_mul_f32 v188, 4.0, v189
  v_mul_f32 v188, v188, v25
  v_cos_f32 v100, v188
  v_sin_f32 v116, v188
  v_add_f32 v188, v188, v189
  v_cos_f32 v101, v188
  v_sin_f32 v117, v188
  v_add_f32 v188, v188, v189
  v_cos_f32 v102, v188
  v_sin_f32 v118, v188
  v_add_f32 v188, v188, v189
  v_cos_f32 v103, v188
  v_sin_f32 v119, v188
  v_add_f32 v188, v188, v190
  v_cos_f32 v104, v188
  v_sin_f32 v120, v188
  v_add_f32 v188, v188, v189
  v_cos_f32 v105, v188
  v_sin_f32 v121, v188
  v_add_f32 v188, v188, v189
  v_cos_f32 v106, v188
  v_sin_f32 v122, v188
  v_add_f32 v188, v188, v189
  v_cos_f32 v107, v188
  v_sin_f32 v123, v188
  v_add_f32 v188, v188, v190
  v_cos_f32 v108, v188
  v_sin_f32 v124, v188
  v_add_f32 v188, v188, v189
  v_cos_f32 v109, v188
  v_sin_f32 v125, v188
  v_add_f32 v188, v188, v189
  v_cos_f32 v110, v188
  v_sin_f32 v126, v188
  v_add_f32 v188, v188, v189
  v_cos_f32 v111, v188
  v_sin_f32 v127, v188
  v_add_f32 v188, v188, v190
  v_cos_f32 v112, v188
  v_sin_f32 v128, v188
  v_add_f32 v188, v188, v189
  v_cos_f32 v113, v188
  v_sin_f32 v129, v188
  v_add_f32 v188, v188, v189
  v_cos_f32 v114, v188
  v_sin_f32 v130, v188
  v_add_f32 v188, v188, v189
  v_cos_f32 v115, v188
  v_sin_f32 v131, v188
  ds_write_b128 v27, v[100:103] offset:6144
  ds_write_b128 v27, v[104:107] offset:7168
  ds_write_b128 v27, v[108:111] offset:8192
  ds_write_b128 v27, v[112:115] offset:9216
  ds_write_b128 v27, v[116:119] offset:10240
  ds_write_b128 v27, v[120:123] offset:11264
  ds_write_b128 v27, v[124:127] offset:12288
  ds_write_b128 v27, v[128:131] offset:13312
  s_branch Lcwj
Lcw3:
  v_mul_f32 v189, 0x3d000000, v24
  v_mul_f32 v190, 0x40a00000, v189
  v_mul_f32 v188, 4.0, v189
  v_mul_f32 v188, v188, v25
  v_cos_f32 v191, v188
  v_sin_f32 v195, v188
  v_add_f32 v188, v188, v189
  v_cos_f32 v192, v188
  v_sin_f32 v196, v188
  v_add_f32 v188, v188, v189
  v_cos_f32 v193, v188
  v_sin_f32 v197, v188
  v_add_f32 v188, v188, v189
  v_cos_f32 v194, v188
  v_sin_f32 v198, v188
  v_cvt_pk_bf16_f32 v150, v191, v192
  v_cvt_pk_bf16_f32 v152, v195, v196
  v_cvt_pk_bf16_f32 v151, v193, v194
  v_cvt_pk_bf16_f32 v153, v197, v198
  v_xor_b32 v148, 0x80008000, v152
  v_xor_b32 v149, 0x80008000, v153
  v_add_f32 v188, v188, v190
  v_cos_f32 v191, v188
  v_sin_f32 v195, v188
  v_add_f32 v188, v188, v189
  v_cos_f32 v192, v188
  v_sin_f32 v196, v188
  v_add_f32 v188, v188, v189
  v_cos_f32 v193, v188
  v_sin_f32 v197, v188
  v_add_f32 v188, v188, v189
  v_cos_f32 v194, v188
  v_sin_f32 v198, v188
  v_cvt_pk_bf16_f32 v160, v191, v192
  v_cvt_pk_bf16_f32 v162, v195, v196
  v_cvt_pk_bf16_f32 v161, v193, v194
  v_cvt_pk_bf16_f32 v163, v197, v198
  v_xor_b32 v158, 0x80008000, v162
  v_xor_b32 v159, 0x80008000, v163
  v_add_f32 v188, v188, v190
  v_cos_f32 v191, v188
  v_sin_f32 v195, v188
  v_add_f32 v188, v188, v189
  v_cos_f32 v192, v188
  v_sin_f32 v196, v188
  v_add_f32 v188, v188, v189
  v_cos_f32 v193, v188
  v_sin_f32 v197, v188
  v_add_f32 v188, v188, v189
  v_cos_f32 v194, v188
  v_sin_f32 v198, v188
  v_cvt_pk_bf16_f32 v170, v191, v192
  v_cvt_pk_bf16_f32 v172, v195, v196
  v_cvt_pk_bf16_f32 v171, v193, v194
  v_cvt_pk_bf16_f32 v173, v197, v198
  v_xor_b32 v168, 0x80008000, v172
  v_xor_b32 v169, 0x80008000, v173
  v_add_f32 v188, v188, v190
  v_cos_f32 v191, v188
  v_sin_f32 v195, v188
  v_add_f32 v188, v188, v189
  v_cos_f32 v192, v188
  v_sin_f32 v196, v188
  v_add_f32 v188, v188, v189
  v_cos_f32 v193, v188
  v_sin_f32 v197, v188
  v_add_f32 v188, v188, v189
  v_cos_f32 v194, v188
  v_sin_f32 v198, v188
  v_cvt_pk_bf16_f32 v180, v191, v192
  v_cvt_pk_bf16_f32 v182, v195, v196
  v_cvt_pk_bf16_f32 v181, v193, v194
  v_cvt_pk_bf16_f32 v183, v197, v198
  v_xor_b32 v178, 0x80008000, v182
  v_xor_b32 v179, 0x80008000, v183
  ds_write_b128 v27, v[148:151] offset:14336
  ds_write_b128 v27, v[158:161] offset:15360
  ds_write_b128 v27, v[168:171] offset:16384
  ds_write_b128 v27, v[178:181] offset:17408
  ds_write_b64 v27, v[152:153] offset:18432
  ds_write_b64 v27, v[162:163] offset:19456
  ds_write_b64 v27, v[172:173] offset:20480
  ds_write_b64 v27, v[182:183] offset:21504
Lcwj:
  v_mov_b32 v42, 0
  v_mov_b32 v43, 0
  v_cvt_f32_u32 v16, s75
  v_mul_f32 v16, 0x3a000000, v16
  v_cos_f32 v244, v16
  v_sin_f32 v248, v16
  v_add_f32 v16, 0x3c800000, v16
  v_cos_f32 v245, v16
  v_sin_f32 v249, v16
  v_add_f32 v16, 0x3c800000, v16
  v_cos_f32 v246, v16
  v_sin_f32 v250, v16
  v_add_f32 v16, 0x3c800000, v16
  v_cos_f32 v247, v16
  v_sin_f32 v251, v16
  s_waitcnt lgkmcnt(0)
  s_barrier
  ds_read_b128 v[44:47], v27 offset:0
  ds_read_b128 v[56:59], v27 offset:1024
  ds_read_b128 v[48:51], v27 offset:2048
  ds_read_b128 v[60:63], v27 offset:3072
  ds_read_b128 v[52:55], v27 offset:4096
  ds_read_b128 v[64:67], v27 offset:5120
  ds_read_b128 v[100:103], v27 offset:6144
  ds_read_b128 v[104:107], v27 offset:7168
  ds_read_b128 v[108:111], v27 offset:8192
  ds_read_b128 v[112:115], v27 offset:9216
  ds_read_b128 v[116:119], v27 offset:10240
  ds_read_b128 v[120:123], v27 offset:11264
  ds_read_b128 v[124:127], v27 offset:12288
  ds_read_b128 v[128:131], v27 offset:13312
  ds_read_b128 v[148:151], v27 offset:14336
  ds_read_b128 v[158:161], v27 offset:15360
  ds_read_b128 v[168:171], v27 offset:16384
  ds_read_b128 v[178:181], v27 offset:17408
  ds_read_b64 v[152:153], v27 offset:18432
  ds_read_b64 v[162:163], v27 offset:19456
  ds_read_b64 v[172:173], v27 offset:20480
  ds_read_b64 v[182:183], v27 offset:21504
  buffer_load_dword a255, v31, s[20:23], s51 offen
  buffer_load_dword a255, v31, s[24:27], s51 offen
  s_mul_i32 s53, s3, 2560
  v_mad_u32_u24 v20, v1, 40, s53
  v_lshrrev_b32 v21, 5, v1
  v_mul_u32_u24 v21, 1280, v21
  v_bfe_u32 v16, v1, 2, 2
  v_lshl_add_u32 v21, v16, 6, v21
  v_bfe_u32 v16, v1, 4, 1
  v_lshl_add_u32 v21, v16, 5, v21
  v_and_b32 v16, 3, v1
  v_lshl_add_u32 v21, v16, 3, v21
  v_add_u32 v21, s53, v21
  v_mov_b32 v199, 0x3acccccd
  s_waitcnt vmcnt(5)
  v_lshlrev_b32 v200, 16, v132
  v_and_b32 v201, 0xffff0000, v132
  v_lshlrev_b32 v202, 16, v133
  v_and_b32 v203, 0xffff0000, v133
  v_lshlrev_b32 v204, 16, v134
  v_and_b32 v205, 0xffff0000, v134
  v_lshlrev_b32 v206, 16, v135
  v_and_b32 v207, 0xffff0000, v135
  v_lshlrev_b32 v208, 16, v136
  v_and_b32 v209, 0xffff0000, v136
  v_lshlrev_b32 v210, 16, v137
  v_and_b32 v211, 0xffff0000, v137
  v_lshlrev_b32 v212, 16, v138
  v_and_b32 v213, 0xffff0000, v138
  v_lshlrev_b32 v214, 16, v139
  v_and_b32 v215, 0xffff0000, v139
  v_lshlrev_b32 v216, 16, v140
  v_and_b32 v217, 0xffff0000, v140
  v_lshlrev_b32 v218, 16, v141
  v_and_b32 v219, 0xffff0000, v141
  v_pk_add_f32 v[16:17], v[200:201], v[202:203]
  v_pk_mul_f32 v[18:19], v[200:201], v[200:201]
  v_pk_fma_f32 v[18:19], v[202:203], v[202:203], v[18:19]
  v_pk_add_f32 v[16:17], v[16:17], v[204:205]
  v_pk_fma_f32 v[18:19], v[204:205], v[204:205], v[18:19]
  v_pk_add_f32 v[16:17], v[16:17], v[206:207]
  v_pk_fma_f32 v[18:19], v[206:207], v[206:207], v[18:19]
  v_pk_add_f32 v[16:17], v[16:17], v[208:209]
  v_pk_fma_f32 v[18:19], v[208:209], v[208:209], v[18:19]
  v_pk_add_f32 v[16:17], v[16:17], v[210:211]
  v_pk_fma_f32 v[18:19], v[210:211], v[210:211], v[18:19]
  v_pk_add_f32 v[16:17], v[16:17], v[212:213]
  v_pk_fma_f32 v[18:19], v[212:213], v[212:213], v[18:19]
  v_pk_add_f32 v[16:17], v[16:17], v[214:215]
  v_pk_fma_f32 v[18:19], v[214:215], v[214:215], v[18:19]
  v_pk_add_f32 v[16:17], v[16:17], v[216:217]
  v_pk_fma_f32 v[18:19], v[216:217], v[216:217], v[18:19]
  v_pk_add_f32 v[16:17], v[16:17], v[218:219]
  v_pk_fma_f32 v[18:19], v[218:219], v[218:219], v[18:19]
  v_add_f32 v16, v16, v17
  v_add_f32 v18, v18, v19
  s_nop 0
  v_add_f32_dpp v16, v16, v16 quad_perm:[1,0,3,2] row_mask:0xf bank_mask:0xf
  v_add_f32_dpp v18, v18, v18 quad_perm:[1,0,3,2] row_mask:0xf bank_mask:0xf
  s_nop 0
  v_add_f32_dpp v16, v16, v16 quad_perm:[2,3,0,1] row_mask:0xf bank_mask:0xf
  v_add_f32_dpp v18, v18, v18 quad_perm:[2,3,0,1] row_mask:0xf bank_mask:0xf
  s_nop 0
  v_add_f32_dpp v16, v16, v16 row_half_mirror row_mask:0xf bank_mask:0xf
  v_add_f32_dpp v18, v18, v18 row_half_mirror row_mask:0xf bank_mask:0xf
  s_nop 0
  v_add_f32_dpp v16, v16, v16 row_mirror row_mask:0xf bank_mask:0xf
  v_add_f32_dpp v18, v18, v18 row_mirror row_mask:0xf bank_mask:0xf
  v_mov_b32 v17, v16
  v_mov_b32 v19, v18
  s_nop 0
  v_permlane16_swap_b32 v16, v17
  v_permlane16_swap_b32 v18, v19
  v_add_f32 v16, v16, v17
  v_add_f32 v18, v18, v19
  v_mul_f32 v16, 0x3acccccd, v16
  v_mul_f32 v17, v16, v16
  v_fma_f32 v17, v18, v199, -v17
  v_max_f32 v17, 0, v17
  v_add_f32 v17, 0x3727c5ac, v17
  v_rsq_f32 v18, v17
  s_nop 0
  v_mul_f32 v18, 0x34cccccd, v18
  v_mul_f32 v16, v16, v18
  v_pk_fma_f32 v[200:201], v[200:201], v[18:19], v[16:17] op_sel_hi:[1,0,0] neg_lo:[0,0,1] neg_hi:[0,0,1]
  v_cvt_pk_bf16_f32 v132, v200, v201
  v_pk_fma_f32 v[202:203], v[202:203], v[18:19], v[16:17] op_sel_hi:[1,0,0] neg_lo:[0,0,1] neg_hi:[0,0,1]
  v_cvt_pk_bf16_f32 v133, v202, v203
  ds_write_b64 v20, v[132:133] offset:20480
  v_pk_fma_f32 v[204:205], v[204:205], v[18:19], v[16:17] op_sel_hi:[1,0,0] neg_lo:[0,0,1] neg_hi:[0,0,1]
  v_cvt_pk_bf16_f32 v134, v204, v205
  v_pk_fma_f32 v[206:207], v[206:207], v[18:19], v[16:17] op_sel_hi:[1,0,0] neg_lo:[0,0,1] neg_hi:[0,0,1]
  v_cvt_pk_bf16_f32 v135, v206, v207
  ds_write_b64 v20, v[134:135] offset:20488
  v_pk_fma_f32 v[208:209], v[208:209], v[18:19], v[16:17] op_sel_hi:[1,0,0] neg_lo:[0,0,1] neg_hi:[0,0,1]
  v_cvt_pk_bf16_f32 v136, v208, v209
  v_pk_fma_f32 v[210:211], v[210:211], v[18:19], v[16:17] op_sel_hi:[1,0,0] neg_lo:[0,0,1] neg_hi:[0,0,1]
  v_cvt_pk_bf16_f32 v137, v210, v211
  ds_write_b64 v20, v[136:137] offset:20496
  v_pk_fma_f32 v[212:213], v[212:213], v[18:19], v[16:17] op_sel_hi:[1,0,0] neg_lo:[0,0,1] neg_hi:[0,0,1]
  v_cvt_pk_bf16_f32 v138, v212, v213
  v_pk_fma_f32 v[214:215], v[214:215], v[18:19], v[16:17] op_sel_hi:[1,0,0] neg_lo:[0,0,1] neg_hi:[0,0,1]
  v_cvt_pk_bf16_f32 v139, v214, v215
  ds_write_b64 v20, v[138:139] offset:20504
  v_pk_fma_f32 v[216:217], v[216:217], v[18:19], v[16:17] op_sel_hi:[1,0,0] neg_lo:[0,0,1] neg_hi:[0,0,1]
  v_cvt_pk_bf16_f32 v140, v216, v217
  v_pk_fma_f32 v[218:219], v[218:219], v[18:19], v[16:17] op_sel_hi:[1,0,0] neg_lo:[0,0,1] neg_hi:[0,0,1]
  v_cvt_pk_bf16_f32 v141, v218, v219
  ds_write_b64 v20, v[140:141] offset:20512
  s_waitcnt lgkmcnt(0)
  ds_read_b64_tr_b16 v[32:33], v21 offset:20480
  ds_read_b64_tr_b16 v[34:35], v21 offset:20736
  ds_read_b64_tr_b16 v[36:37], v21 offset:20992
  ds_read_b64_tr_b16 v[38:39], v21 offset:21248
  ds_read_b64_tr_b16 v[40:41], v21 offset:21504
  buffer_load_dword v236, off, s[40:43], 0 sc1
  s_waitcnt lgkmcnt(0)
  v_mfma_f32_32x32x16_bf16 v[68:83], v[32:35], v[44:47], 0
  s_mov_b32 s16, s64
  s_mov_b32 s17, s65
  s_mov_b32 s18, 0x280000
  s_mov_b32 s19, 0x20000
  s_mov_b32 s28, s60
  v_mfma_f32_32x32x16_bf16 v[84:99], v[32:35], v[56:59], 0
  s_mov_b32 s29, s61
  s_mov_b32 s30, 0x1e0000
  s_mov_b32 s31, 0x20000
  s_mov_b32 s32, s62
  s_mov_b32 s33, s63
  v_mfma_f32_32x32x16_bf16 v[68:83], v[36:39], v[48:51], v[68:83]
  s_mov_b32 s34, 0x1e0000
  s_mov_b32 s35, 0x20000
  s_add_u32 s36, s68, 11304960
  s_addc_u32 s37, s69, 0
  s_mov_b32 s38, 2621440
  v_mfma_f32_32x32x16_bf16 v[84:99], v[36:39], v[60:63], v[84:99]
  s_mov_b32 s39, 0x20000
  v_lshrrev_b32 v22, 5, v1
  v_lshlrev_b32 v23, 4, v22
  v_lshlrev_b32 v22, 9, v22
  v_bfe_u32 v16, v1, 2, 2
  v_mfma_f32_32x32x16_bf16 v[68:83], v[40:43], v[52:55], v[68:83]
  v_lshl_add_u32 v22, v16, 6, v22
  v_bfe_u32 v16, v1, 4, 1
  v_lshl_add_u32 v22, v16, 5, v22
  v_and_b32 v16, 3, v1
  v_lshl_add_u32 v22, v16, 3, v22
  v_mfma_f32_32x32x16_bf16 v[84:99], v[40:43], v[64:67], v[84:99]
  s_mul_i32 s53, s3, 3072
  v_add_u32 v22, s53, v22
  v_and_b32 v16, 31, v1
  v_lshl_add_u32 v23, v16, 5, v23
  s_lshl_b32 s53, s3, 10
  s_nop 0
  v_pk_mul_f32 v[188:189], v[68:69], v[100:101]
  s_nop 4
  v_pk_mul_f32 v[190:191], v[84:85], v[100:101]
  v_pk_fma_f32 v[188:189], v[84:85], v[116:117], v[188:189]
  v_pk_fma_f32 v[190:191], v[68:69], v[116:117], v[190:191] neg_lo:[0,1,0] neg_hi:[0,1,0]
  v_cvt_pk_bf16_f32 v132, v188, v189
  v_cvt_pk_bf16_f32 v134, v190, v191
  v_pk_mul_f32 v[192:193], v[70:71], v[102:103]
  v_pk_mul_f32 v[194:195], v[86:87], v[102:103]
  v_pk_fma_f32 v[192:193], v[86:87], v[118:119], v[192:193]
  v_pk_fma_f32 v[194:195], v[70:71], v[118:119], v[194:195] neg_lo:[0,1,0] neg_hi:[0,1,0]
  v_cvt_pk_bf16_f32 v133, v192, v193
  v_cvt_pk_bf16_f32 v135, v194, v195
  v_pk_mul_f32 v[188:189], v[72:73], v[104:105]
  v_pk_mul_f32 v[190:191], v[88:89], v[104:105]
  v_pk_fma_f32 v[188:189], v[88:89], v[120:121], v[188:189]
  v_pk_fma_f32 v[190:191], v[72:73], v[120:121], v[190:191] neg_lo:[0,1,0] neg_hi:[0,1,0]
  v_cvt_pk_bf16_f32 v136, v188, v189
  v_cvt_pk_bf16_f32 v138, v190, v191
  v_pk_mul_f32 v[192:193], v[74:75], v[106:107]
  v_pk_mul_f32 v[194:195], v[90:91], v[106:107]
  v_pk_fma_f32 v[192:193], v[90:91], v[122:123], v[192:193]
  v_pk_fma_f32 v[194:195], v[74:75], v[122:123], v[194:195] neg_lo:[0,1,0] neg_hi:[0,1,0]
  v_cvt_pk_bf16_f32 v137, v192, v193
  v_cvt_pk_bf16_f32 v139, v194, v195
  v_pk_mul_f32 v[188:189], v[76:77], v[108:109]
  v_pk_mul_f32 v[190:191], v[92:93], v[108:109]
  v_pk_fma_f32 v[188:189], v[92:93], v[124:125], v[188:189]
  v_pk_fma_f32 v[190:191], v[76:77], v[124:125], v[190:191] neg_lo:[0,1,0] neg_hi:[0,1,0]
  v_cvt_pk_bf16_f32 v140, v188, v189
  v_cvt_pk_bf16_f32 v142, v190, v191
  v_pk_mul_f32 v[192:193], v[78:79], v[110:111]
  v_pk_mul_f32 v[194:195], v[94:95], v[110:111]
  v_pk_fma_f32 v[192:193], v[94:95], v[126:127], v[192:193]
  v_pk_fma_f32 v[194:195], v[78:79], v[126:127], v[194:195] neg_lo:[0,1,0] neg_hi:[0,1,0]
  v_cvt_pk_bf16_f32 v141, v192, v193
  v_cvt_pk_bf16_f32 v143, v194, v195
  v_pk_mul_f32 v[188:189], v[80:81], v[112:113]
  v_pk_mul_f32 v[190:191], v[96:97], v[112:113]
  v_pk_fma_f32 v[188:189], v[96:97], v[128:129], v[188:189]
  v_pk_fma_f32 v[190:191], v[80:81], v[128:129], v[190:191] neg_lo:[0,1,0] neg_hi:[0,1,0]
  v_cvt_pk_bf16_f32 v144, v188, v189
  v_cvt_pk_bf16_f32 v146, v190, v191
  v_pk_mul_f32 v[192:193], v[82:83], v[114:115]
  v_pk_mul_f32 v[194:195], v[98:99], v[114:115]
  v_pk_fma_f32 v[192:193], v[98:99], v[130:131], v[192:193]
  v_pk_fma_f32 v[194:195], v[82:83], v[130:131], v[194:195] neg_lo:[0,1,0] neg_hi:[0,1,0]
  v_cvt_pk_bf16_f32 v145, v192, v193
  v_cvt_pk_bf16_f32 v147, v194, v195
  v_mfma_f32_32x32x16_bf16 v[68:83], v[132:135], v[150:153], 0
  v_add_u32 v23, s53, v23
  s_lshl_b32 s53, s3, 29
  s_and_b32 s53, s53, 0x40000000
  v_or_b32 v30, s53, v23
  v_and_b32 v28, 31, v1
  v_mfma_f32_32x32x16_bf16 v[84:99], v[132:135], v[148:151], 0
  v_lshrrev_b32 v16, 5, v1
  v_lshl_add_u32 v28, v28, 1, v16
  v_mul_u32_u24 v28, 40, v28
  s_mul_i32 s53, s3, 5120
  v_add_u32 v28, s53, v28
  v_mfma_f32_32x32x16_bf16 v[68:83], v[136:139], v[160:163], v[68:83]
  v_lshl_add_u32 v24, v0, 2, 4
  v_sub_u32 v25, 2560, v24
  v_lshlrev_b32 v26, 2, v1
  v_add_u32 v26, 1028, v26
  v_sub_u32 v27, 2560, v26
  v_mfma_f32_32x32x16_bf16 v[84:99], v[136:139], v[158:161], v[84:99]
  s_mul_i32 s60, s2, 10240
  s_waitcnt vmcnt(3)
  ds_read_b64_tr_b16 v[220:221], v22 offset:30720
  ds_read_b64_tr_b16 v[222:223], v22 offset:30976
  ds_read_b64_tr_b16 v[224:225], v22 offset:31744
  v_mfma_f32_32x32x16_bf16 v[68:83], v[140:143], v[170:173], v[68:83]
  ds_read_b64_tr_b16 v[226:227], v22 offset:32000
  ds_read_b64_tr_b16 v[228:229], v22 offset:32768
  ds_read_b64_tr_b16 v[230:231], v22 offset:33024
  s_add_u32 s53, s60, 3407872
  s_add_u32 s54, s60, 3411968
  v_mfma_f32_32x32x16_bf16 v[84:99], v[140:143], v[168:171], v[84:99]
  s_add_u32 s55, s60, 3416064
  s_nop 0
  s_nop 0
  s_waitcnt lgkmcnt(0)
  buffer_store_dwordx4 v[220:223], v23, s[8:11], s53 offen sc1
  v_mfma_f32_32x32x16_bf16 v[68:83], v[144:147], v[180:183], v[68:83]
  buffer_store_dwordx4 v[224:227], v23, s[8:11], s54 offen sc1
  buffer_store_dwordx4 v[228:231], v30, s[8:11], s55 offen sc1
  v_mfma_f32_32x32x16_bf16 v[84:99], v[144:147], v[178:181], v[84:99]
  s_nop 8
  ds_write_b64 v28, v[68:69] offset:0
  ds_write_b64 v28, v[70:71] offset:8
  ds_write_b64 v28, v[72:73] offset:16
  ds_write_b64 v28, v[74:75] offset:24
  ds_write_b64 v28, v[76:77] offset:32
  ds_write_b64 v28, v[84:85] offset:2560
  ds_write_b64 v28, v[86:87] offset:2568
  ds_write_b64 v28, v[88:89] offset:2576
  ds_write_b64 v28, v[90:91] offset:2584
  ds_write_b64 v28, v[92:93] offset:2592
  s_waitcnt lgkmcnt(0)
  s_barrier
  ds_read2st64_b32 v[68:69], v24 offset0:0 offset1:20
  ds_read2st64_b32 v[76:77], v25 offset0:0 offset1:20
  ds_read2st64_b32 v[72:73], v24 offset0:10 offset1:30
  ds_read2st64_b32 v[80:81], v25 offset0:10 offset1:30
  ds_read2st64_b32 v[70:71], v24 offset0:40 offset1:60
  ds_read2st64_b32 v[78:79], v25 offset0:40 offset1:60
  ds_read2st64_b32 v[74:75], v24 offset0:50 offset1:70
  ds_read2st64_b32 v[82:83], v25 offset0:50 offset1:70
  s_add_u32 s53, s60, 786432
  s_add_u32 s54, s60, 791552
  s_waitcnt lgkmcnt(4)
  v_pk_add_f32 v[84:85], v[68:69], v[76:77]
  v_pk_add_f32 v[90:91], v[76:77], v[68:69] neg_lo:[0,1] neg_hi:[0,1]
  v_pk_add_f32 v[86:87], v[72:73], v[80:81] neg_lo:[0,1] neg_hi:[0,1]
  v_pk_add_f32 v[88:89], v[72:73], v[80:81]
  v_pk_add_f32 v[92:93], v[84:85], v[88:89]
  v_pk_add_f32 v[94:95], v[86:87], v[90:91]
  v_pk_add_f32 v[84:85], v[84:85], v[88:89] neg_lo:[0,1] neg_hi:[0,1]
  v_pk_add_f32 v[86:87], v[86:87], v[90:91] neg_lo:[0,1] neg_hi:[0,1]
  v_cvt_pk_bf16_f32 v200, v92, v93
  v_cvt_pk_bf16_f32 v202, v94, v95
  v_pk_mul_f32 v[88:89], v[84:85], v[244:245]
  v_pk_mul_f32 v[90:91], v[86:87], v[244:245]
  v_pk_fma_f32 v[88:89], v[86:87], v[248:249], v[88:89]
  v_pk_fma_f32 v[90:91], v[84:85], v[248:249], v[90:91] neg_lo:[0,1,0] neg_hi:[0,1,0]
  v_cvt_pk_bf16_f32 v204, v88, v89
  v_cvt_pk_bf16_f32 v206, v90, v91
  s_waitcnt lgkmcnt(0)
  v_pk_add_f32 v[84:85], v[70:71], v[78:79]
  v_pk_add_f32 v[90:91], v[78:79], v[70:71] neg_lo:[0,1] neg_hi:[0,1]
  v_pk_add_f32 v[86:87], v[74:75], v[82:83] neg_lo:[0,1] neg_hi:[0,1]
  v_pk_add_f32 v[88:89], v[74:75], v[82:83]
  v_pk_add_f32 v[92:93], v[84:85], v[88:89]
  v_pk_add_f32 v[94:95], v[86:87], v[90:91]
  v_pk_add_f32 v[84:85], v[84:85], v[88:89] neg_lo:[0,1] neg_hi:[0,1]
  v_pk_add_f32 v[86:87], v[86:87], v[90:91] neg_lo:[0,1] neg_hi:[0,1]
  v_cvt_pk_bf16_f32 v201, v92, v93
  v_cvt_pk_bf16_f32 v203, v94, v95
  v_pk_mul_f32 v[88:89], v[84:85], v[246:247]
  v_pk_mul_f32 v[90:91], v[86:87], v[246:247]
  v_pk_fma_f32 v[88:89], v[86:87], v[250:251], v[88:89]
  v_pk_fma_f32 v[90:91], v[84:85], v[250:251], v[90:91] neg_lo:[0,1,0] neg_hi:[0,1,0]
  v_cvt_pk_bf16_f32 v205, v88, v89
  v_cvt_pk_bf16_f32 v207, v90, v91
  buffer_store_dwordx4 v[200:203], v29, s[8:11], s53 offen sc1
  buffer_store_dwordx4 v[204:207], v29, s[8:11], s54 offen sc1
  s_cmp_lg_u32 s3, 3
  s_nop 0
  s_cbranch_scc1 Lnou2
  ds_read2st64_b32 v[68:69], v26 offset0:0 offset1:20
  ds_read2st64_b32 v[76:77], v27 offset0:0 offset1:20
  ds_read2st64_b32 v[72:73], v26 offset0:10 offset1:30
  ds_read2st64_b32 v[80:81], v27 offset0:10 offset1:30
  ds_read2st64_b32 v[70:71], v26 offset0:40 offset1:60
  ds_read2st64_b32 v[78:79], v27 offset0:40 offset1:60
  ds_read2st64_b32 v[74:75], v26 offset0:50 offset1:70
  ds_read2st64_b32 v[82:83], v27 offset0:50 offset1:70
  s_add_u32 s53, s60, 790528
  s_add_u32 s54, s60, 795648
  s_waitcnt lgkmcnt(4)
  v_pk_add_f32 v[84:85], v[68:69], v[76:77]
  v_pk_add_f32 v[90:91], v[76:77], v[68:69] neg_lo:[0,1] neg_hi:[0,1]
  v_pk_add_f32 v[86:87], v[72:73], v[80:81] neg_lo:[0,1] neg_hi:[0,1]
  v_pk_add_f32 v[88:89], v[72:73], v[80:81]
  v_pk_add_f32 v[92:93], v[84:85], v[88:89]
  v_pk_add_f32 v[94:95], v[86:87], v[90:91]
  v_pk_add_f32 v[84:85], v[84:85], v[88:89] neg_lo:[0,1] neg_hi:[0,1]
  v_pk_add_f32 v[86:87], v[86:87], v[90:91] neg_lo:[0,1] neg_hi:[0,1]
  v_cvt_pk_bf16_f32 v200, v92, v93
  v_cvt_pk_bf16_f32 v202, v94, v95
  v_pk_mul_f32 v[88:89], v[84:85], v[244:245]
  v_pk_mul_f32 v[90:91], v[86:87], v[244:245]
  v_pk_fma_f32 v[88:89], v[86:87], v[248:249], v[88:89]
  v_pk_fma_f32 v[90:91], v[84:85], v[248:249], v[90:91] neg_lo:[0,1,0] neg_hi:[0,1,0]
  v_cvt_pk_bf16_f32 v204, v88, v89
  v_cvt_pk_bf16_f32 v206, v90, v91
  s_waitcnt lgkmcnt(0)
  v_pk_add_f32 v[84:85], v[70:71], v[78:79]
  v_pk_add_f32 v[90:91], v[78:79], v[70:71] neg_lo:[0,1] neg_hi:[0,1]
  v_pk_add_f32 v[86:87], v[74:75], v[82:83] neg_lo:[0,1] neg_hi:[0,1]
  v_pk_add_f32 v[88:89], v[74:75], v[82:83]
  v_pk_add_f32 v[92:93], v[84:85], v[88:89]
  v_pk_add_f32 v[94:95], v[86:87], v[90:91]
  v_pk_add_f32 v[84:85], v[84:85], v[88:89] neg_lo:[0,1] neg_hi:[0,1]
  v_pk_add_f32 v[86:87], v[86:87], v[90:91] neg_lo:[0,1] neg_hi:[0,1]
  v_cvt_pk_bf16_f32 v201, v92, v93
  v_cvt_pk_bf16_f32 v203, v94, v95
  v_pk_mul_f32 v[88:89], v[84:85], v[246:247]
  v_pk_mul_f32 v[90:91], v[86:87], v[246:247]
  v_pk_fma_f32 v[88:89], v[86:87], v[250:251], v[88:89]
  v_pk_fma_f32 v[90:91], v[84:85], v[250:251], v[90:91] neg_lo:[0,1,0] neg_hi:[0,1,0]
  v_cvt_pk_bf16_f32 v205, v88, v89
  v_cvt_pk_bf16_f32 v207, v90, v91
  buffer_store_dwordx4 v[200:203], v2, s[8:11], s53 offen sc1
  buffer_store_dwordx4 v[204:207], v2, s[8:11], s54 offen sc1
  s_nop 1
Lnou2:
  s_and_b32 s53, s46, 1
  s_lshl_b32 s53, s53, 1
  v_add_u32 v16, 0, v1
  v_mul_u32_u24 v17, 6554, v16
  v_lshrrev_b32 v17, 16, v17
  v_mul_u32_u24 v18, 10, v17
  v_sub_u32 v18, v16, v18
  v_add_u32 v18, s53, v18
  v_subrev_u32 v19, 10, v18
  v_min_u32 v18, v18, v19
  v_lshrrev_b32 v19, 1, v17
  v_xor_b32 v19, v19, v17
  v_and_b32 v19, 4, v19
  v_mul_u32_u24 v19, 3, v19
  v_xor_b32 v17, v17, v19
  v_mul_u32_u24 v17, 1280, v17
  v_lshl_add_u32 v6, v18, 4, v17
  v_add_u32 v16, 64, v1
  v_mul_u32_u24 v17, 6554, v16
  v_lshrrev_b32 v17, 16, v17
  v_mul_u32_u24 v18, 10, v17
  v_sub_u32 v18, v16, v18
  v_add_u32 v18, s53, v18
  v_subrev_u32 v19, 10, v18
  v_min_u32 v18, v18, v19
  v_lshrrev_b32 v19, 1, v17
  v_xor_b32 v19, v19, v17
  v_and_b32 v19, 4, v19
  v_mul_u32_u24 v19, 3, v19
  v_xor_b32 v17, v17, v19
  v_mul_u32_u24 v17, 1280, v17
  v_lshl_add_u32 v7, v18, 4, v17
  v_add_u32 v16, 128, v1
  v_mul_u32_u24 v17, 6554, v16
  v_lshrrev_b32 v17, 16, v17
  v_mul_u32_u24 v18, 10, v17
  v_sub_u32 v18, v16, v18
  v_add_u32 v18, s53, v18
  v_subrev_u32 v19, 10, v18
  v_min_u32 v18, v18, v19
  v_lshrrev_b32 v19, 1, v17
  v_xor_b32 v19, v19, v17
  v_and_b32 v19, 4, v19
  v_mul_u32_u24 v19, 3, v19
  v_xor_b32 v17, v17, v19
  v_mul_u32_u24 v17, 1280, v17
  v_lshl_add_u32 v8, v18, 4, v17
  v_add_u32 v16, 192, v1
  v_mul_u32_u24 v17, 6554, v16
  v_lshrrev_b32 v17, 16, v17
  v_mul_u32_u24 v18, 10, v17
  v_sub_u32 v18, v16, v18
  v_add_u32 v18, s53, v18
  v_subrev_u32 v19, 10, v18
  v_min_u32 v18, v18, v19
  v_lshrrev_b32 v19, 1, v17
  v_xor_b32 v19, v19, v17
  v_and_b32 v19, 4, v19
  v_mul_u32_u24 v19, 3, v19
  v_xor_b32 v17, v17, v19
  v_mul_u32_u24 v17, 1280, v17
  v_lshl_add_u32 v9, v18, 4, v17
  v_add_u32 v16, 256, v1
  v_mul_u32_u24 v17, 6554, v16
  v_lshrrev_b32 v17, 16, v17
  v_mul_u32_u24 v18, 10, v17
  v_sub_u32 v18, v16, v18
  v_add_u32 v18, s53, v18
  v_subrev_u32 v19, 10, v18
  v_min_u32 v18, v18, v19
  v_lshrrev_b32 v19, 1, v17
  v_xor_b32 v19, v19, v17
  v_and_b32 v19, 4, v19
  v_mul_u32_u24 v19, 3, v19
  v_xor_b32 v17, v17, v19
  v_mul_u32_u24 v17, 1280, v17
  v_lshl_add_u32 v10, v18, 4, v17
  s_and_b32 s53, s3, 1
  s_lshl_b32 s53, s53, 1
  v_add_u32 v16, 0, v1
  v_mul_u32_u24 v17, 10923, v16
  v_lshrrev_b32 v17, 16, v17
  v_mul_u32_u24 v18, 6, v17
  v_sub_u32 v18, v16, v18
  v_add_u32 v18, s53, v18
  v_subrev_u32 v19, 6, v18
  v_min_u32 v18, v18, v19
  v_lshrrev_b32 v19, 1, v17
  v_xor_b32 v19, v19, v17
  v_and_b32 v19, 4, v19
  v_mul_u32_u24 v19, 3, v19
  v_xor_b32 v17, v17, v19
  v_mul_u32_u24 v17, 3072, v17
  v_lshl_add_u32 v11, v18, 4, v17
  v_add_u32 v16, 64, v1
  v_mul_u32_u24 v17, 10923, v16
  v_lshrrev_b32 v17, 16, v17
  v_mul_u32_u24 v18, 6, v17
  v_sub_u32 v18, v16, v18
  v_add_u32 v18, s53, v18
  v_subrev_u32 v19, 6, v18
  v_min_u32 v18, v18, v19
  v_lshrrev_b32 v19, 1, v17
  v_xor_b32 v19, v19, v17
  v_and_b32 v19, 4, v19
  v_mul_u32_u24 v19, 3, v19
  v_xor_b32 v17, v17, v19
  v_mul_u32_u24 v17, 3072, v17
  v_lshl_add_u32 v12, v18, 4, v17
  v_add_u32 v16, 128, v1
  v_mul_u32_u24 v17, 10923, v16
  v_lshrrev_b32 v17, 16, v17
  v_mul_u32_u24 v18, 6, v17
  v_sub_u32 v18, v16, v18
  v_add_u32 v18, s53, v18
  v_subrev_u32 v19, 6, v18
  v_min_u32 v18, v18, v19
  v_lshrrev_b32 v19, 1, v17
  v_xor_b32 v19, v19, v17
  v_and_b32 v19, 4, v19
  v_mul_u32_u24 v19, 3, v19
  v_xor_b32 v17, v17, v19
  v_mul_u32_u24 v17, 3072, v17
  v_lshl_add_u32 v13, v18, 4, v17
  s_mul_i32 s47, s3, 25600
  s_add_u32 s47, s47, 61440
  v_bfe_u32 v16, v1, 2, 3
  v_lshrrev_b32 v17, 5, v1
  v_lshl_add_u32 v16, v17, 4, v16
  v_and_b32 v17, 3, v1
  v_lshlrev_b32 v17, 3, v17
  v_add_u32 v17, s47, v17
  v_mad_u32_u24 v14, v16, 40, 0
  v_lshl_add_u32 v14, v14, 2, v17
  v_mad_u32_u24 v15, v16, 24, 0
  v_lshl_add_u32 v15, v15, 2, v17
  s_mul_i32 s53, s46, 160
  s_mul_i32 s48, s3, 204800
  s_add_u32 s48, s48, s53
  s_mul_i32 s50, s3, 491520
  s_add_u32 s50, s50, s53
  s_mul_i32 s53, s46, 384
  s_mul_i32 s49, s3, 96
  s_add_u32 s49, s49, s53
  s_add_u32 s51, s48, 0
  s_add_u32 m0, s47, 0
  s_nop 0
  buffer_load_dwordx4 v6, s[20:23], s51 offen lds
  s_addk_i32 m0, 1024
  s_nop 0
  buffer_load_dwordx4 v7, s[20:23], s51 offen lds
  s_addk_i32 m0, 1024
  s_nop 0
  buffer_load_dwordx4 v8, s[20:23], s51 offen lds
  s_addk_i32 m0, 1024
  s_nop 0
  buffer_load_dwordx4 v9, s[20:23], s51 offen lds
  s_addk_i32 m0, 1024
  s_nop 0
  buffer_load_dwordx4 v10, s[20:23], s51 offen lds
  s_waitcnt vmcnt(10)
  s_mov_b32 s54, 0
Ltag:
  v_readfirstlane_b32 s44, v236
  s_add_u32 s54, s54, 1
  s_cmp_gt_u32 s54, 200000
  s_nop 2
  s_cbranch_scc1 Ltagok
  s_cmp_lg_u32 s44, 0
  s_cbranch_scc1 Ltagok
  buffer_load_dword v236, off, s[40:43], 0 sc1
  s_waitcnt vmcnt(0)
  s_branch Ltag
Ltagok:
  v_mov_b32 v154, v150
  v_mov_b32 v156, v148
  v_mov_b32 v155, v151
  v_mov_b32 v157, v149
  v_mov_b32 v164, v160
  v_mov_b32 v166, v158
  v_mov_b32 v165, v161
  v_mov_b32 v167, v159
  v_mov_b32 v174, v170
  v_mov_b32 v176, v168
  v_mov_b32 v175, v171
  v_mov_b32 v177, v169
  v_mov_b32 v184, v180
  v_mov_b32 v186, v178
  v_mov_b32 v185, v181
  v_mov_b32 v187, v179
  v_lshlrev_b32 v248, 5, v0
  s_lshl_b32 s61, s79, 2
  s_add_u32 s62, s61, s3
  s_mul_i32 s62, s62, 1280
  s_add_u32 s63, s62, 1310720
  v_and_b32 v20, 31, v1
  v_lshrrev_b32 v21, 5, v1
  v_lshl_add_u32 v20, v20, 1, v21
  v_mul_u32_u24 v20, 20, v20
  buffer_load_dwordx4 a[240:243], v20, s[4:7], s62 offen
  buffer_load_dword a244, v20, s[4:7], s62 offen offset:16
  buffer_load_dwordx4 a[246:249], v20, s[4:7], s63 offen
  buffer_load_dword a250, v20, s[4:7], s63 offen offset:16
  v_mov_b32 v20, 0x80008000
  v_mul_lo_u32 v20, v20, v21
  v_xor_b32 v21, 0x80008000, v20
  v_xor_b32 v44, v20, v44
  v_xor_b32 v56, v21, v56
  v_xor_b32 v45, v20, v45
  v_xor_b32 v57, v21, v57
  v_xor_b32 v46, v20, v46
  v_xor_b32 v58, v21, v58
  v_xor_b32 v47, v20, v47
  v_xor_b32 v59, v21, v59
  v_xor_b32 v48, v20, v48
  v_xor_b32 v60, v21, v60
  v_xor_b32 v49, v20, v49
  v_xor_b32 v61, v21, v61
  v_xor_b32 v50, v20, v50
  v_xor_b32 v62, v21, v62
  v_xor_b32 v51, v20, v51
  v_xor_b32 v63, v21, v63
  v_xor_b32 v52, v20, v52
  v_xor_b32 v64, v21, v64
  v_xor_b32 v53, v20, v53
  v_xor_b32 v65, v21, v65
  s_waitcnt vmcnt(9)
  s_barrier
  s_cmp_lg_u32 s3, 0
  s_cbranch_scc1 Lsig1
  s_add_u32 s53, s44, 1
  s_lshl_b32 s54, s2, 5
  s_add_u32 s54, s54, 262144
  v_mov_b32 v16, s53
  v_lshlrev_b32 v17, 13, v1
  s_mov_b64 exec, 15
  buffer_store_dword v16, v17, s[8:11], s54 offen sc1
  s_mov_b64 exec, 1
  s_mov_b64 exec, -1
Lsig1:
  s_cmp_ge_u32 s2, 160
  s_cbranch_scc1 Lk2skip
  v_lshrrev_b32 v250, 3, v1
  v_mul_u32_u24 v254, 20480, v250
  v_lshrrev_b32 v250, 1, v250
  s_add_u32 s51, s48, 40960
  v_sub_u32 v251, v1, v250
  v_and_b32 v255, 7, v251
  v_lshl_add_u32 v255, v255, 4, v254
  s_add_u32 m0, s47, 5120
  v_xor_b32 v254, 64, v255
  v_lshrrev_b32 v250, 2, v1
  v_mul_u32_u24 v252, 10240, v250
  buffer_load_dwordx4 v6, s[20:23], s51 offen lds
  v_sub_u32 v251, v1, v5
  v_and_b32 v251, 3, v251
  v_lshl_add_u32 v252, v251, 4, v252
  s_addk_i32 m0, 1024
  v_add_u32 v251, s3, v250
  v_and_b32 v251, 3, v251
  v_lshlrev_b32 v251, 4, v251
  buffer_load_dwordx4 v7, s[20:23], s51 offen lds
  v_lshl_add_u32 v249, v1, 6, v251
  v_lshrrev_b32 v250, 1, v1
  s_lshl_b32 s53, s3, 1
  s_addk_i32 m0, 1024
  v_add_u32 v250, s53, v250
  v_and_b32 v251, 7, v250
  v_lshlrev_b32 v251, 4, v251
  buffer_load_dwordx4 v8, s[20:23], s51 offen lds
  v_lshl_add_u32 v253, v1, 7, v251
  v_add_u32 v250, 1, v250
  v_and_b32 v251, 7, v250
  s_addk_i32 m0, 1024
  v_lshlrev_b32 v251, 4, v251
  v_lshl_add_u32 v34, v1, 7, v251
  s_lshl_b32 s72, s3, 12
  buffer_load_dwordx4 v9, s[20:23], s51 offen lds
  s_and_b32 s60, s2, 1
  s_lshr_b32 s61, s2, 4
  s_lshl_b32 s61, s61, 3
  s_addk_i32 m0, 1024
  s_and_b32 s62, s2, 6
  s_add_u32 s61, s61, s62
  s_bfe_u32 s62, s2, 0x10003
  buffer_load_dwordx4 v10, s[20:23], s51 offen lds
  s_add_u32 s61, s61, s62
  s_mul_i32 s62, s60, 5120
  s_lshl_b32 s63, s61, 6
  s_add_u32 s62, s62, s63
  s_mul_i32 s63, s3, 655360
  s_add_u32 s64, s62, s63
  s_add_u32 s51, s48, 81920
  s_add_u32 s64, s64, 786432
  s_mul_i32 s62, s60, 10240
  s_lshl_b32 s61, s61, 7
  s_add_u32 m0, s47, 10240
  s_add_u32 s62, s62, s61
  s_add_u32 s68, s62, s63
  s_add_u32 s68, s68, 3407872
  buffer_load_dwordx4 v6, s[20:23], s51 offen lds
  s_add_u32 s65, s64, 163840
  s_add_u32 s69, s68, 163840
  s_add_u32 s66, s64, 327680
  s_addk_i32 m0, 1024
  s_add_u32 s70, s68, 327680
  s_add_u32 s67, s64, 491520
  s_add_u32 s71, s68, 491520
  buffer_load_dwordx4 v7, s[20:23], s51 offen lds
  v_and_b32 v250, 31, v1
  v_lshrrev_b32 v251, 5, v1
  s_addk_i32 m0, 1024
  v_cvt_f32_u32 v250, v250
  v_cvt_f32_u32 v251, v251
  v_mul_f32 v189, 0x3a800000, v250
  buffer_load_dwordx4 v8, s[20:23], s51 offen lds
  v_mul_f32 v190, 0x40a00000, v189
  v_mul_f32 v188, 4.0, v189
  v_mul_f32 v188, v188, v251
  s_addk_i32 m0, 1024
  v_cos_f32 v232, v188
  v_sin_f32 v132, v188
  v_add_f32 v188, v188, v189
  buffer_load_dwordx4 v9, s[20:23], s51 offen lds
  v_cos_f32 v233, v188
  v_sin_f32 v133, v188
  v_add_f32 v188, v188, v189
  s_addk_i32 m0, 1024
  v_cos_f32 v234, v188
  v_sin_f32 v134, v188
  v_add_f32 v188, v188, v189
  buffer_load_dwordx4 v10, s[20:23], s51 offen lds
  v_cos_f32 v235, v188
  v_sin_f32 v135, v188
  v_add_f32 v188, v188, v190
  v_cos_f32 v236, v188
  v_sin_f32 v136, v188
  v_add_f32 v188, v188, v189
  s_add_u32 s51, s48, 122880
  v_cos_f32 v237, v188
  v_sin_f32 v137, v188
  v_add_f32 v188, v188, v189
  s_add_u32 m0, s47, 15360
  v_cos_f32 v238, v188
  v_sin_f32 v138, v188
  v_add_f32 v188, v188, v189
  buffer_load_dwordx4 v6, s[20:23], s51 offen lds
  v_cos_f32 v239, v188
  v_sin_f32 v139, v188
  v_add_f32 v188, v188, v190
  s_addk_i32 m0, 1024
  v_cos_f32 v240, v188
  v_sin_f32 v140, v188
  v_add_f32 v188, v188, v189
  buffer_load_dwordx4 v7, s[20:23], s51 offen lds
  v_cos_f32 v241, v188
  v_sin_f32 v141, v188
  v_add_f32 v188, v188, v189
  s_addk_i32 m0, 1024
  v_cos_f32 v242, v188
  v_sin_f32 v142, v188
  v_add_f32 v188, v188, v189
  buffer_load_dwordx4 v8, s[20:23], s51 offen lds
  v_cos_f32 v243, v188
  v_sin_f32 v143, v188
  v_add_f32 v188, v188, v190
  s_addk_i32 m0, 1024
  v_cos_f32 v244, v188
  v_sin_f32 v144, v188
  v_add_f32 v188, v188, v189
  buffer_load_dwordx4 v9, s[20:23], s51 offen lds
  v_cos_f32 v245, v188
  v_sin_f32 v145, v188
  v_add_f32 v188, v188, v189
  s_addk_i32 m0, 1024
  v_cos_f32 v246, v188
  v_sin_f32 v146, v188
  v_add_f32 v188, v188, v189
  buffer_load_dwordx4 v10, s[20:23], s51 offen lds
  v_cos_f32 v247, v188
  v_sin_f32 v147, v188
  s_add_u32 s53, s44, 1
  s_mov_b32 s54, 0
  s_and_b32 s55, s2, 3
  s_lshl_b32 s55, s55, 13
  s_add_u32 s55, s55, 262144
  s_mov_b64 exec, -1
Lpoll2:
  buffer_load_dword v16, v248, s[8:11], s55 offen sc1
  s_add_u32 s54, s54, 1
  s_waitcnt vmcnt(0)
  v_subrev_u32 v16, s53, v16
  v_cmp_lt_u32 vcc, 7, v16
  s_cmp_gt_u32 s54, 200000
  s_nop 3
  s_cbranch_scc1 Lpdone3
  s_cbranch_vccz Lpdone3
  s_mov_b64 exec, vcc
  s_branch Lpoll2
Lpdone3:
  s_mov_b64 exec, -1
  s_mov_b32 m0, s72
  s_nop 0
  buffer_load_dwordx4 v252, s[8:11], s64 offen sc1 lds
  s_addk_i32 m0, 1024
  s_nop 0
  buffer_load_dwordx4 v252, s[8:11], s65 offen sc1 lds
  s_addk_i32 m0, 1024
  s_nop 0
  buffer_load_dwordx4 v252, s[8:11], s66 offen sc1 lds
  s_addk_i32 m0, 1024
  s_nop 0
  buffer_load_dwordx4 v252, s[8:11], s67 offen sc1 lds
  s_addk_i32 m0, 13568
  s_nop 0
  buffer_load_dwordx4 v255, s[8:11], s68 offen sc1 lds
  s_addk_i32 m0, 1024
  s_nop 0
  buffer_load_dwordx4 v254, s[8:11], s69 offen sc1 lds
  s_addk_i32 m0, 1024
  s_nop 0
  buffer_load_dwordx4 v255, s[8:11], s70 offen sc1 lds
  s_addk_i32 m0, 1024
  s_nop 0
  buffer_load_dwordx4 v254, s[8:11], s71 offen sc1 lds
  v_mov_b32 v16, v132
  v_mov_b32 v17, v133
  v_mov_b32 v18, v134
  v_mov_b32 v19, v135
  v_mov_b32 v20, v136
  v_mov_b32 v21, v137
  v_mov_b32 v22, v138
  v_mov_b32 v23, v139
  v_mov_b32 v24, v140
  v_mov_b32 v25, v141
  v_mov_b32 v26, v142
  v_mov_b32 v27, v143
  v_mov_b32 v28, v144
  v_mov_b32 v29, v145
  v_mov_b32 v30, v146
  v_mov_b32 v31, v147
  s_waitcnt vmcnt(28)
  ds_read_b64_tr_b16 a[0:1], v14 offset:0
  ds_read_b64_tr_b16 a[2:3], v14 offset:1280
  ds_read_b64_tr_b16 a[4:5], v14 offset:32
  ds_read_b64_tr_b16 a[6:7], v14 offset:1312
  ds_read_b64_tr_b16 a[8:9], v14 offset:64
  ds_read_b64_tr_b16 a[10:11], v14 offset:1344
  ds_read_b64_tr_b16 a[12:13], v14 offset:96
  ds_read_b64_tr_b16 a[14:15], v14 offset:1376
  ds_read_b64_tr_b16 a[16:17], v14 offset:128
  ds_read_b64_tr_b16 a[18:19], v14 offset:1408
  s_waitcnt vmcnt(19)
  ds_read_b64_tr_b16 a[20:21], v14 offset:5120
  ds_read_b64_tr_b16 a[22:23], v14 offset:6400
  ds_read_b64_tr_b16 a[24:25], v14 offset:5152
  ds_read_b64_tr_b16 a[26:27], v14 offset:6432
  ds_read_b64_tr_b16 a[28:29], v14 offset:5184
  ds_read_b64_tr_b16 a[30:31], v14 offset:6464
  ds_read_b64_tr_b16 a[32:33], v14 offset:5216
  ds_read_b64_tr_b16 a[34:35], v14 offset:6496
  ds_read_b64_tr_b16 a[36:37], v14 offset:5248
  ds_read_b64_tr_b16 a[38:39], v14 offset:6528
  s_waitcnt vmcnt(14)
  ds_read_b64_tr_b16 a[40:41], v14 offset:10240
  ds_read_b64_tr_b16 a[42:43], v14 offset:11520
  ds_read_b64_tr_b16 a[44:45], v14 offset:10272
  ds_read_b64_tr_b16 a[46:47], v14 offset:11552
  ds_read_b64_tr_b16 a[48:49], v14 offset:10304
  ds_read_b64_tr_b16 a[50:51], v14 offset:11584
  ds_read_b64_tr_b16 a[52:53], v14 offset:10336
  ds_read_b64_tr_b16 a[54:55], v14 offset:11616
  ds_read_b64_tr_b16 a[56:57], v14 offset:10368
  ds_read_b64_tr_b16 a[58:59], v14 offset:11648
  s_waitcnt vmcnt(9)
  ds_read_b64_tr_b16 a[60:61], v14 offset:15360
  ds_read_b64_tr_b16 a[62:63], v14 offset:16640
  ds_read_b64_tr_b16 a[64:65], v14 offset:15392
  ds_read_b64_tr_b16 a[66:67], v14 offset:16672
  ds_read_b64_tr_b16 a[68:69], v14 offset:15424
  ds_read_b64_tr_b16 a[70:71], v14 offset:16704
  ds_read_b64_tr_b16 a[72:73], v14 offset:15456
  ds_read_b64_tr_b16 a[74:75], v14 offset:16736
  ds_read_b64_tr_b16 a[76:77], v14 offset:15488
  ds_read_b64_tr_b16 a[78:79], v14 offset:16768
  s_waitcnt vmcnt(4)
  s_waitcnt lgkmcnt(0)
  s_barrier
  ds_read_b128 v[132:135], v249 offset:0
  ds_read_b128 v[136:139], v249 offset:4096
  ds_read_b128 v[140:143], v249 offset:8192
  ds_read_b128 v[144:147], v249 offset:12288
  s_waitcnt lgkmcnt(0)
  v_mfma_f32_32x32x16_bf16 v[68:83], v[132:135], v[150:153], 0
  s_add_u32 s51, s48, 163840
  s_add_u32 m0, s47, 20480
  v_mfma_f32_32x32x16_bf16 v[84:99], v[132:135], v[148:151], 0
  buffer_load_dwordx4 v6, s[20:23], s51 offen lds
  s_addk_i32 m0, 1024
  v_mfma_f32_32x32x16_bf16 v[68:83], v[136:139], v[160:163], v[68:83]
  buffer_load_dwordx4 v7, s[20:23], s51 offen lds
  s_addk_i32 m0, 1024
  v_mfma_f32_32x32x16_bf16 v[84:99], v[136:139], v[158:161], v[84:99]
  buffer_load_dwordx4 v8, s[20:23], s51 offen lds
  s_addk_i32 m0, 1024
  v_mfma_f32_32x32x16_bf16 v[68:83], v[140:143], v[170:173], v[68:83]
  buffer_load_dwordx4 v9, s[20:23], s51 offen lds
  s_addk_i32 m0, 1024
  v_mfma_f32_32x32x16_bf16 v[84:99], v[140:143], v[168:171], v[84:99]
  buffer_load_dwordx4 v10, s[20:23], s51 offen lds
  s_waitcnt lgkmcnt(4)
  v_mfma_f32_32x32x16_bf16 v[68:83], v[144:147], v[180:183], v[68:83]
  s_add_u32 s51, s48, 0
  s_add_u32 m0, s47, 0
  v_mfma_f32_32x32x16_bf16 v[84:99], v[144:147], v[178:181], v[84:99]
  buffer_load_dwordx4 v6, s[24:27], s51 offen lds
  s_addk_i32 m0, 1024
  s_nop 6
  v_pk_mul_f32 v[188:189], v[68:69], v[232:233]
  s_nop 1
  v_pk_mul_f32 v[190:191], v[84:85], v[232:233]
  v_pk_fma_f32 v[188:189], v[84:85], v[16:17], v[188:189]
  v_pk_fma_f32 v[190:191], v[68:69], v[16:17], v[190:191] neg_lo:[0,1,0] neg_hi:[0,1,0]
  v_cvt_pk_bf16_f32 v132, v188, v189
  v_cvt_pk_bf16_f32 v134, v190, v191
  v_pk_mul_f32 v[192:193], v[70:71], v[234:235]
  v_pk_mul_f32 v[194:195], v[86:87], v[234:235]
  v_pk_fma_f32 v[192:193], v[86:87], v[18:19], v[192:193]
  v_pk_fma_f32 v[194:195], v[70:71], v[18:19], v[194:195] neg_lo:[0,1,0] neg_hi:[0,1,0]
  v_cvt_pk_bf16_f32 v133, v192, v193
  v_cvt_pk_bf16_f32 v135, v194, v195
  v_pk_mul_f32 v[188:189], v[72:73], v[236:237]
  v_pk_mul_f32 v[190:191], v[88:89], v[236:237]
  v_pk_fma_f32 v[188:189], v[88:89], v[20:21], v[188:189]
  v_pk_fma_f32 v[190:191], v[72:73], v[20:21], v[190:191] neg_lo:[0,1,0] neg_hi:[0,1,0]
  v_cvt_pk_bf16_f32 v136, v188, v189
  v_cvt_pk_bf16_f32 v138, v190, v191
  v_pk_mul_f32 v[192:193], v[74:75], v[238:239]
  v_pk_mul_f32 v[194:195], v[90:91], v[238:239]
  v_pk_fma_f32 v[192:193], v[90:91], v[22:23], v[192:193]
  v_pk_fma_f32 v[194:195], v[74:75], v[22:23], v[194:195] neg_lo:[0,1,0] neg_hi:[0,1,0]
  v_cvt_pk_bf16_f32 v137, v192, v193
  v_cvt_pk_bf16_f32 v139, v194, v195
  v_pk_mul_f32 v[188:189], v[76:77], v[240:241]
  v_pk_mul_f32 v[190:191], v[92:93], v[240:241]
  v_pk_fma_f32 v[188:189], v[92:93], v[24:25], v[188:189]
  v_pk_fma_f32 v[190:191], v[76:77], v[24:25], v[190:191] neg_lo:[0,1,0] neg_hi:[0,1,0]
  v_cvt_pk_bf16_f32 v140, v188, v189
  v_cvt_pk_bf16_f32 v142, v190, v191
  v_pk_mul_f32 v[192:193], v[78:79], v[242:243]
  v_pk_mul_f32 v[194:195], v[94:95], v[242:243]
  v_pk_fma_f32 v[192:193], v[94:95], v[26:27], v[192:193]
  v_pk_fma_f32 v[194:195], v[78:79], v[26:27], v[194:195] neg_lo:[0,1,0] neg_hi:[0,1,0]
  v_cvt_pk_bf16_f32 v141, v192, v193
  v_cvt_pk_bf16_f32 v143, v194, v195
  v_pk_mul_f32 v[188:189], v[80:81], v[244:245]
  v_pk_mul_f32 v[190:191], v[96:97], v[244:245]
  v_pk_fma_f32 v[188:189], v[96:97], v[28:29], v[188:189]
  v_pk_fma_f32 v[190:191], v[80:81], v[28:29], v[190:191] neg_lo:[0,1,0] neg_hi:[0,1,0]
  v_cvt_pk_bf16_f32 v144, v188, v189
  v_cvt_pk_bf16_f32 v146, v190, v191
  v_pk_mul_f32 v[192:193], v[82:83], v[246:247]
  v_pk_mul_f32 v[194:195], v[98:99], v[246:247]
  v_pk_fma_f32 v[192:193], v[98:99], v[30:31], v[192:193]
  v_pk_fma_f32 v[194:195], v[82:83], v[30:31], v[194:195] neg_lo:[0,1,0] neg_hi:[0,1,0]
  v_cvt_pk_bf16_f32 v145, v192, v193
  s_waitcnt vmcnt(6)
  v_cvt_pk_bf16_f32 v147, v194, v195
  s_waitcnt lgkmcnt(0)
  s_barrier
  ds_read_b128 v[208:211], v253 offset:16640
  ds_read_b128 v[212:215], v34 offset:16640
  ds_read_b128 v[224:227], v253 offset:24832
  ds_read_b128 v[228:231], v34 offset:24832
  v_mfma_f32_32x32x16_bf16 v[68:83], v[150:153], v[132:135], 0
  v_mfma_f32_32x32x16_bf16 v[84:99], v[148:151], v[132:135], 0
  v_mfma_f32_32x32x16_bf16 v[68:83], v[160:163], v[136:139], v[68:83]
  s_waitcnt lgkmcnt(0)
  v_lshlrev_b32 v200, 16, v208
  v_and_b32 v201, 0xffff0000, v208
  v_lshlrev_b32 v202, 16, v209
  v_and_b32 v203, 0xffff0000, v209
  v_lshlrev_b32 v204, 16, v210
  v_mfma_f32_32x32x16_bf16 v[84:99], v[158:161], v[136:139], v[84:99]
  v_and_b32 v205, 0xffff0000, v210
  v_lshlrev_b32 v206, 16, v211
  v_and_b32 v207, 0xffff0000, v211
  v_lshlrev_b32 v208, 16, v212
  v_and_b32 v209, 0xffff0000, v212
  v_lshlrev_b32 v210, 16, v213
  v_mfma_f32_32x32x16_bf16 v[68:83], v[170:173], v[140:143], v[68:83]
  v_and_b32 v211, 0xffff0000, v213
  v_lshlrev_b32 v212, 16, v214
  v_and_b32 v213, 0xffff0000, v214
  v_lshlrev_b32 v214, 16, v215
  v_and_b32 v215, 0xffff0000, v215
  v_lshlrev_b32 v216, 16, v224
  v_mfma_f32_32x32x16_bf16 v[84:99], v[168:171], v[140:143], v[84:99]
  v_and_b32 v217, 0xffff0000, v224
  v_lshlrev_b32 v218, 16, v225
  v_and_b32 v219, 0xffff0000, v225
  v_lshlrev_b32 v220, 16, v226
  v_and_b32 v221, 0xffff0000, v226
  v_lshlrev_b32 v222, 16, v227
  v_mfma_f32_32x32x16_bf16 v[68:83], v[180:183], v[144:147], v[68:83]
  v_and_b32 v223, 0xffff0000, v227
  v_lshlrev_b32 v224, 16, v228
  v_and_b32 v225, 0xffff0000, v228
  v_lshlrev_b32 v226, 16, v229
  v_and_b32 v227, 0xffff0000, v229
  v_lshlrev_b32 v228, 16, v230
  v_mfma_f32_32x32x16_bf16 v[84:99], v[178:181], v[144:147], v[84:99]
  v_and_b32 v229, 0xffff0000, v230
  v_lshlrev_b32 v230, 16, v231
  v_and_b32 v231, 0xffff0000, v231
  s_nop 1
  v_pk_mul_f32 v[188:189], v[68:69], v[200:201]
  s_nop 5
  v_pk_mul_f32 v[190:191], v[84:85], v[200:201]
  v_pk_fma_f32 v[188:189], v[84:85], v[216:217], v[188:189] neg_lo:[0,1,0] neg_hi:[0,1,0]
  v_pk_fma_f32 v[190:191], v[68:69], v[216:217], v[190:191]
  v_cvt_pk_bf16_f32 v132, v188, v189
  v_cvt_pk_bf16_f32 v134, v190, v191
  v_pk_mul_f32 v[192:193], v[70:71], v[202:203]
  v_pk_mul_f32 v[194:195], v[86:87], v[202:203]
  v_pk_fma_f32 v[192:193], v[86:87], v[218:219], v[192:193] neg_lo:[0,1,0] neg_hi:[0,1,0]
  v_pk_fma_f32 v[194:195], v[70:71], v[218:219], v[194:195]
  v_cvt_pk_bf16_f32 v133, v192, v193
  v_cvt_pk_bf16_f32 v135, v194, v195
  v_pk_mul_f32 v[188:189], v[72:73], v[204:205]
  v_pk_mul_f32 v[190:191], v[88:89], v[204:205]
  v_pk_fma_f32 v[188:189], v[88:89], v[220:221], v[188:189] neg_lo:[0,1,0] neg_hi:[0,1,0]
  v_pk_fma_f32 v[190:191], v[72:73], v[220:221], v[190:191]
  v_cvt_pk_bf16_f32 v136, v188, v189
  v_cvt_pk_bf16_f32 v138, v190, v191
  v_pk_mul_f32 v[192:193], v[74:75], v[206:207]
  v_pk_mul_f32 v[194:195], v[90:91], v[206:207]
  v_pk_fma_f32 v[192:193], v[90:91], v[222:223], v[192:193] neg_lo:[0,1,0] neg_hi:[0,1,0]
  v_pk_fma_f32 v[194:195], v[74:75], v[222:223], v[194:195]
  v_cvt_pk_bf16_f32 v137, v192, v193
  v_cvt_pk_bf16_f32 v139, v194, v195
  v_pk_mul_f32 v[188:189], v[76:77], v[208:209]
  v_pk_mul_f32 v[190:191], v[92:93], v[208:209]
  v_pk_fma_f32 v[188:189], v[92:93], v[224:225], v[188:189] neg_lo:[0,1,0] neg_hi:[0,1,0]
  v_pk_fma_f32 v[190:191], v[76:77], v[224:225], v[190:191]
  v_cvt_pk_bf16_f32 v140, v188, v189
  v_cvt_pk_bf16_f32 v142, v190, v191
  v_pk_mul_f32 v[192:193], v[78:79], v[210:211]
  v_pk_mul_f32 v[194:195], v[94:95], v[210:211]
  v_pk_fma_f32 v[192:193], v[94:95], v[226:227], v[192:193] neg_lo:[0,1,0] neg_hi:[0,1,0]
  v_pk_fma_f32 v[194:195], v[78:79], v[226:227], v[194:195]
  v_cvt_pk_bf16_f32 v141, v192, v193
  v_cvt_pk_bf16_f32 v143, v194, v195
  v_pk_mul_f32 v[188:189], v[80:81], v[212:213]
  v_pk_mul_f32 v[190:191], v[96:97], v[212:213]
  v_pk_fma_f32 v[188:189], v[96:97], v[228:229], v[188:189] neg_lo:[0,1,0] neg_hi:[0,1,0]
  v_pk_fma_f32 v[190:191], v[80:81], v[228:229], v[190:191]
  v_cvt_pk_bf16_f32 v144, v188, v189
  v_cvt_pk_bf16_f32 v146, v190, v191
  v_pk_mul_f32 v[192:193], v[82:83], v[214:215]
  v_pk_mul_f32 v[194:195], v[98:99], v[214:215]
  v_pk_fma_f32 v[192:193], v[98:99], v[230:231], v[192:193] neg_lo:[0,1,0] neg_hi:[0,1,0]
  v_pk_fma_f32 v[194:195], v[82:83], v[230:231], v[194:195]
  v_cvt_pk_bf16_f32 v145, v192, v193
  v_cvt_pk_bf16_f32 v147, v194, v195
  v_mfma_f32_32x32x16_bf16 v[68:83], v[132:135], v[154:157], 0
  buffer_load_dwordx4 v7, s[24:27], s51 offen lds
  s_addk_i32 m0, 1024
  s_nop 0
  buffer_load_dwordx4 v8, s[24:27], s51 offen lds
  v_mfma_f32_32x32x16_bf16 v[84:99], v[132:135], v[152:155], 0
  s_addk_i32 m0, 1024
  s_nop 0
  buffer_load_dwordx4 v9, s[24:27], s51 offen lds
  s_addk_i32 m0, 1024
  v_mfma_f32_32x32x16_bf16 v[68:83], v[136:139], v[164:167], v[68:83]
  buffer_load_dwordx4 v10, s[24:27], s51 offen lds
  s_add_u32 s51, s48, 40960
  s_add_u32 m0, s47, 5120
  v_mfma_f32_32x32x16_bf16 v[84:99], v[136:139], v[162:165], v[84:99]
  buffer_load_dwordx4 v6, s[24:27], s51 offen lds
  s_addk_i32 m0, 1024
  s_nop 0
  buffer_load_dwordx4 v7, s[24:27], s51 offen lds
  v_mfma_f32_32x32x16_bf16 v[68:83], v[140:143], v[174:177], v[68:83]
  s_addk_i32 m0, 1024
  s_nop 0
  buffer_load_dwordx4 v8, s[24:27], s51 offen lds
  s_addk_i32 m0, 1024
  v_mfma_f32_32x32x16_bf16 v[84:99], v[140:143], v[172:175], v[84:99]
  buffer_load_dwordx4 v9, s[24:27], s51 offen lds
  s_addk_i32 m0, 1024
  s_nop 0
  buffer_load_dwordx4 v10, s[24:27], s51 offen lds
  v_mfma_f32_32x32x16_bf16 v[68:83], v[144:147], v[184:187], v[68:83]
  s_add_u32 s51, s48, 81920
  s_add_u32 m0, s47, 10240
  s_nop 0
  buffer_load_dwordx4 v6, s[24:27], s51 offen lds
  v_mfma_f32_32x32x16_bf16 v[84:99], v[144:147], v[182:185], v[84:99]
  s_addk_i32 m0, 1024
  s_nop 0
  buffer_load_dwordx4 v7, s[24:27], s51 offen lds
  s_addk_i32 m0, 1024
  s_nop 2
  v_pk_mul_f32 v[188:189], v[68:69], v[232:233]
  s_nop 3
  v_pk_mul_f32 v[190:191], v[84:85], v[232:233]
  v_pk_fma_f32 v[188:189], v[84:85], v[16:17], v[188:189] neg_lo:[0,1,0] neg_hi:[0,1,0]
  v_pk_fma_f32 v[190:191], v[68:69], v[16:17], v[190:191]
  v_cvt_pk_bf16_f32 v132, v188, v189
  v_cvt_pk_bf16_f32 v134, v190, v191
  v_pk_mul_f32 v[192:193], v[70:71], v[234:235]
  v_pk_mul_f32 v[194:195], v[86:87], v[234:235]
  v_pk_fma_f32 v[192:193], v[86:87], v[18:19], v[192:193] neg_lo:[0,1,0] neg_hi:[0,1,0]
  v_pk_fma_f32 v[194:195], v[70:71], v[18:19], v[194:195]
  v_cvt_pk_bf16_f32 v133, v192, v193
  v_cvt_pk_bf16_f32 v135, v194, v195
  v_pk_mul_f32 v[188:189], v[72:73], v[236:237]
  v_pk_mul_f32 v[190:191], v[88:89], v[236:237]
  v_pk_fma_f32 v[188:189], v[88:89], v[20:21], v[188:189] neg_lo:[0,1,0] neg_hi:[0,1,0]
  v_pk_fma_f32 v[190:191], v[72:73], v[20:21], v[190:191]
  v_cvt_pk_bf16_f32 v136, v188, v189
  v_cvt_pk_bf16_f32 v138, v190, v191
  v_pk_mul_f32 v[192:193], v[74:75], v[238:239]
  v_pk_mul_f32 v[194:195], v[90:91], v[238:239]
  v_pk_fma_f32 v[192:193], v[90:91], v[22:23], v[192:193] neg_lo:[0,1,0] neg_hi:[0,1,0]
  v_pk_fma_f32 v[194:195], v[74:75], v[22:23], v[194:195]
  v_cvt_pk_bf16_f32 v137, v192, v193
  v_cvt_pk_bf16_f32 v139, v194, v195
  v_pk_mul_f32 v[188:189], v[76:77], v[240:241]
  v_pk_mul_f32 v[190:191], v[92:93], v[240:241]
  v_pk_fma_f32 v[188:189], v[92:93], v[24:25], v[188:189] neg_lo:[0,1,0] neg_hi:[0,1,0]
  v_pk_fma_f32 v[190:191], v[76:77], v[24:25], v[190:191]
  v_cvt_pk_bf16_f32 v140, v188, v189
  v_cvt_pk_bf16_f32 v142, v190, v191
  v_pk_mul_f32 v[192:193], v[78:79], v[242:243]
  v_pk_mul_f32 v[194:195], v[94:95], v[242:243]
  v_pk_fma_f32 v[192:193], v[94:95], v[26:27], v[192:193] neg_lo:[0,1,0] neg_hi:[0,1,0]
  v_pk_fma_f32 v[194:195], v[78:79], v[26:27], v[194:195]
  v_cvt_pk_bf16_f32 v141, v192, v193
  v_cvt_pk_bf16_f32 v143, v194, v195
  v_pk_mul_f32 v[188:189], v[80:81], v[244:245]
  v_pk_mul_f32 v[190:191], v[96:97], v[244:245]
  v_pk_fma_f32 v[188:189], v[96:97], v[28:29], v[188:189] neg_lo:[0,1,0] neg_hi:[0,1,0]
  v_pk_fma_f32 v[190:191], v[80:81], v[28:29], v[190:191]
  v_cvt_pk_bf16_f32 v144, v188, v189
  v_cvt_pk_bf16_f32 v146, v190, v191
  v_pk_mul_f32 v[192:193], v[82:83], v[246:247]
  v_pk_mul_f32 v[194:195], v[98:99], v[246:247]
  v_pk_fma_f32 v[192:193], v[98:99], v[30:31], v[192:193] neg_lo:[0,1,0] neg_hi:[0,1,0]
  v_pk_fma_f32 v[194:195], v[82:83], v[30:31], v[194:195]
  v_cvt_pk_bf16_f32 v145, v192, v193
  v_cvt_pk_bf16_f32 v147, v194, v195
  v_mfma_f32_32x32x16_bf16 v[68:83], v[132:135], v[154:157], 0
  v_and_b32 v249, 31, v1
  v_lshrrev_b32 v250, 5, v1
  v_mul_u32_u24 v250, 544, v250
  v_lshl_add_u32 v249, v249, 4, v250
  s_mul_i32 s53, s3, 4416
  v_mfma_f32_32x32x16_bf16 v[84:99], v[132:135], v[152:155], 0
  v_add_u32 v249, s53, v249
  v_and_b32 v251, 3, v1
  v_mul_u32_u24 v253, 4416, v251
  v_bfe_u32 v251, v1, 2, 1
  v_mul_u32_u24 v251, 544, v251
  v_mfma_f32_32x32x16_bf16 v[68:83], v[136:139], v[164:167], v[68:83]
  v_add_u32 v253, v253, v251
  v_lshrrev_b32 v250, 3, v1
  v_lshl_add_u32 v253, v250, 4, v253
  s_mul_i32 s53, s3, 1088
  v_add_u32 v253, s53, v253
  v_mfma_f32_32x32x16_bf16 v[84:99], v[136:139], v[162:165], v[84:99]
  v_mul_u32_u24 v252, 81920, v250
  v_and_b32 v251, 0x70, v2
  v_add_u32 v252, v252, v251
  s_mul_i32 s63, s3, 20480
  s_add_u32 s64, s62, s63
  v_mfma_f32_32x32x16_bf16 v[68:83], v[140:143], v[174:177], v[68:83]
  s_add_u32 s64, s64, 6029312
  s_add_u32 s65, s64, 655360
  s_add_u32 s66, s64, 1310720
  s_add_u32 s67, s64, 1966080
  buffer_load_dwordx4 v8, s[24:27], s51 offen lds
  v_mfma_f32_32x32x16_bf16 v[84:99], v[140:143], v[172:175], v[84:99]
  s_addk_i32 m0, 1024
  s_nop 0
  buffer_load_dwordx4 v9, s[24:27], s51 offen lds
  s_addk_i32 m0, 1024
  s_nop 0
  buffer_load_dwordx4 v10, s[24:27], s51 offen lds
  v_mfma_f32_32x32x16_bf16 v[68:83], v[144:147], v[184:187], v[68:83]
  v_mfma_f32_32x32x16_bf16 v[84:99], v[144:147], v[182:185], v[84:99]
  s_nop 10
  v_cvt_pk_bf16_f32 v132, v68, v69
  v_cvt_pk_bf16_f32 v134, v84, v85
  v_cvt_pk_bf16_f32 v133, v70, v71
  v_cvt_pk_bf16_f32 v135, v86, v87
  ds_write_b128 v249, v[132:135] offset:33280
  v_cvt_pk_bf16_f32 v136, v72, v73
  v_cvt_pk_bf16_f32 v138, v88, v89
  v_cvt_pk_bf16_f32 v137, v74, v75
  v_cvt_pk_bf16_f32 v139, v90, v91
  ds_write_b128 v249, v[136:139] offset:34368
  v_cvt_pk_bf16_f32 v140, v76, v77
  v_cvt_pk_bf16_f32 v142, v92, v93
  v_cvt_pk_bf16_f32 v141, v78, v79
  v_cvt_pk_bf16_f32 v143, v94, v95
  ds_write_b128 v249, v[140:143] offset:35456
  v_cvt_pk_bf16_f32 v144, v80, v81
  v_cvt_pk_bf16_f32 v146, v96, v97
  v_cvt_pk_bf16_f32 v145, v82, v83
  v_cvt_pk_bf16_f32 v147, v98, v99
  ds_write_b128 v249, v[144:147] offset:36544
  s_waitcnt lgkmcnt(0)
  s_barrier
  ds_read_b128 v[132:135], v253 offset:33280
  ds_read_b128 v[136:139], v253 offset:33408
  ds_read_b128 v[140:143], v253 offset:33536
  ds_read_b128 v[144:147], v253 offset:33664
  s_waitcnt lgkmcnt(3)
  buffer_store_dwordx4 v[132:135], v252, s[8:11], s64 offen sc1
  s_waitcnt lgkmcnt(2)
  buffer_store_dwordx4 v[136:139], v252, s[8:11], s65 offen sc1
  s_waitcnt lgkmcnt(1)
  buffer_store_dwordx4 v[140:143], v252, s[8:11], s66 offen sc1
  s_waitcnt lgkmcnt(0)
  buffer_store_dwordx4 v[144:147], v252, s[8:11], s67 offen sc1
  s_lshr_b32 s60, s79, 1
  s_mul_i32 s60, s60, 20480
  s_and_b32 s61, s79, 1
  s_add_u32 s51, s48, 122880
  s_lshl_b32 s61, s61, 6
  s_add_u32 s60, s60, s61
  s_add_u32 m0, s47, 15360
  s_add_u32 s60, s60, 6029312
  s_add_u32 s64, s60, 10240
  buffer_load_dwordx4 v6, s[24:27], s51 offen lds
  s_lshl_b32 s61, s3, 11
  s_sub_u32 s65, s60, s61
  s_addk_i32 m0, 1024
  s_add_u32 s65, s65, 8192
  s_add_u32 s66, s65, 10240
  buffer_load_dwordx4 v7, s[24:27], s51 offen lds
  v_lshrrev_b32 v28, 2, v0
  v_lshlrev_b32 v28, 7, v28
  s_addk_i32 m0, 1024
  v_and_b32 v21, 3, v0
  v_lshl_add_u32 v28, v21, 4, v28
  buffer_load_dwordx4 v8, s[24:27], s51 offen lds
  s_lshl_b32 s61, s79, 2
  v_cvt_f32_u32 v22, s61
  s_addk_i32 m0, 1024
  v_mul_f32 v22, 0x3a000000, v22
  v_cos_f32 v244, v22
  buffer_load_dwordx4 v9, s[24:27], s51 offen lds
  v_sin_f32 v248, v22
  v_add_f32 v22, 0x3a000000, v22
  v_cos_f32 v245, v22
  s_addk_i32 m0, 1024
  v_sin_f32 v249, v22
  v_add_f32 v22, 0x3a000000, v22
  buffer_load_dwordx4 v10, s[24:27], s51 offen lds
  v_cos_f32 v246, v22
  v_sin_f32 v250, v22
  v_add_f32 v22, 0x3a000000, v22
  v_cos_f32 v247, v22
  s_waitcnt vmcnt(24)
  v_sin_f32 v251, v22
  v_and_b32 v20, 31, v1
  ds_read_b64_tr_b16 a[80:81], v14 offset:20480
  v_lshrrev_b32 v22, 5, v1
  v_lshl_add_u32 v20, v20, 1, v22
  ds_read_b64_tr_b16 a[82:83], v14 offset:21760
  s_mul_i32 s53, s3, 1344
  s_add_u32 s53, s53, 12288
  ds_read_b64_tr_b16 a[84:85], v14 offset:20512
  v_mad_u32_u24 v24, v20, 20, s53
  v_mul_u32_u24 v21, 1344, v21
  ds_read_b64_tr_b16 a[86:87], v14 offset:21792
  v_lshrrev_b32 v22, 2, v0
  v_lshl_add_u32 v25, v22, 4, v21
  ds_read_b64_tr_b16 a[88:89], v14 offset:20544
  v_add_u32 v26, 1024, v25
  v_add_u32 v27, 5120, v25
  v_cmp_gt_u32 vcc, 64, v0
  ds_read_b64_tr_b16 a[90:91], v14 offset:21824
  s_nop 0
  v_cndmask_b32 v26, v27, v26, vcc
  v_add_u32 v27, 6144, v25
  ds_read_b64_tr_b16 a[92:93], v14 offset:20576
  v_lshlrev_b32 v22, 4, v0
  v_add_u32 v22, 8704, v22
  ds_read_b64_tr_b16 a[94:95], v14 offset:21856
  v_min_u32 v22, 10864, v22
  v_cmp_gt_u32 vcc, 128, v0
  ds_read_b64_tr_b16 a[96:97], v14 offset:20608
  s_nop 0
  v_cndmask_b32 v27, v22, v27, vcc
  v_cmp_eq_u32 vcc, 63, v1
  ds_read_b64_tr_b16 a[98:99], v14 offset:21888
  v_lshl_add_u32 v252, v0, 1, 2
  v_sub_u32 v253, 1280, v252
  v_lshlrev_b32 v254, 1, v1
  v_sub_u32 v255, 766, v254
  s_waitcnt vmcnt(19)
  v_add_u32 v254, 514, v254
  v_cndmask_b32 v255, v255, 0, vcc
  ds_read_b64_tr_b16 a[100:101], v14 offset:0
  v_cndmask_b32 v30, 1.0, 0, vcc
  v_lshlrev_b32 v29, 4, v0
  ds_read_b64_tr_b16 a[102:103], v14 offset:1280
  s_mul_i32 s53, s3, 2560
  v_lshrrev_b32 v31, 5, v1
  v_mul_u32_u24 v31, 1280, v31
  ds_read_b64_tr_b16 a[104:105], v14 offset:32
  v_bfe_u32 v16, v1, 2, 2
  v_lshl_add_u32 v31, v16, 6, v31
  ds_read_b64_tr_b16 a[106:107], v14 offset:1312
  v_bfe_u32 v16, v1, 4, 1
  v_lshl_add_u32 v31, v16, 5, v31
  ds_read_b64_tr_b16 a[108:109], v14 offset:64
  v_and_b32 v16, 3, v1
  v_lshl_add_u32 v31, v16, 3, v31
  ds_read_b64_tr_b16 a[110:111], v14 offset:1344
  v_add_u32 v31, s53, v31
  s_lshl_b32 s53, s3, 10
  ds_read_b64_tr_b16 a[112:113], v14 offset:96
  v_lshlrev_b32 v20, 5, v1
  v_add_u32 v21, 3072, v20
  ds_read_b64_tr_b16 a[114:115], v14 offset:1376
  v_add_u32 v20, s53, v20
  v_cmp_lt_u32 vcc, 31, v1
  ds_read_b64_tr_b16 a[116:117], v14 offset:128
  s_nop 0
  v_cndmask_b32 v20, v20, v21, vcc
  s_mov_b32 s56, -1
  ds_read_b64_tr_b16 a[118:119], v14 offset:1408
  s_cmp_ge_u32 s3, 2
  s_cselect_b32 s57, -1, 0
  s_waitcnt vmcnt(5)
  s_barrier
  s_cmp_lg_u32 s3, 0
  s_cbranch_scc1 Lsig4
  s_add_u32 s53, s44, 2
  s_lshl_b32 s54, s2, 5
  s_add_u32 s54, s54, 524288
  v_mov_b32 v16, s53
  v_lshlrev_b32 v17, 13, v1
  s_mov_b64 exec, 15
  buffer_store_dword v16, v17, s[8:11], s54 offen sc1
  s_mov_b64 exec, 1
  s_mov_b64 exec, -1
Lsig4:
  s_branch Lk2join
Lk2skip:
  v_mul_u32_u24 v16, 5462, v1
  v_lshrrev_b32 v16, 16, v16
  v_mul_u32_u24 v17, 12, v16
  v_sub_u32 v17, v1, v17
  v_mul_u32_u24 v16, 3072, v16
  v_lshl_add_u32 v18, v17, 7, v16
  v_cmp_gt_u32 vcc, 60, v1
  v_mov_b32 v16, 0x40000000
  s_nop 0
  v_cndmask_b32 v18, v16, v18, vcc
  v_mul_u32_u24 v16, 13108, v1
  v_lshrrev_b32 v16, 16, v16
  v_mul_u32_u24 v17, 5, v16
  v_sub_u32 v17, v1, v17
  v_mul_u32_u24 v16, 1280, v16
  v_lshl_add_u32 v19, v17, 7, v16
  v_cmp_gt_u32 vcc, 60, v1
  v_mov_b32 v16, 0x40000000
  s_nop 0
  v_cndmask_b32 v19, v16, v19, vcc
  s_sub_u32 s53, s2, 160
  s_lshr_b32 s53, s53, 3
  s_lshl_b32 s53, s53, 2
  s_add_u32 s53, s53, s3
  s_bfe_u32 s54, s2, 0x20001
  s_lshl_b32 s54, s54, 5
  s_add_u32 s53, s53, s54
  s_and_b32 s54, s2, 1
  s_mul_i32 s55, s54, 1536
  s_mul_i32 s56, s54, 640
  s_sub_u32 s72, s2, 160
  s_lshl_b32 s72, s72, 2
  s_add_u32 s72, s72, s3
  v_lshrrev_b32 v252, 3, v1
  v_mul_u32_u24 v252, 1280, v252
  v_and_b32 v253, 0x70, v2
  v_add_u32 v252, v252, v253
  s_lshl_b32 s73, s3, 13
  s_add_u32 s73, s73, 24576
  v_lshlrev_b32 v250, 10, v5
  v_bfe_u32 v251, v1, 2, 2
  v_lshl_add_u32 v250, v251, 7, v250
  v_and_b32 v251, 3, v1
  v_lshl_add_u32 v250, v251, 3, v250
  v_add_u32 v250, s73, v250
  s_add_u32 s57, s53, 0
  s_and_b32 s57, s57, 127
  s_mul_i32 s57, s57, 15360
  s_add_u32 s57, s57, s55
  buffer_load_dword a255, v18, s[28:31], s57 offen
  s_add_u32 s62, s72, 0
  s_mul_i32 s66, s62, 6554
  s_lshr_b32 s66, s66, 16
  s_mul_i32 s67, s66, 10
  s_sub_u32 s67, s62, s67
  s_lshl_b32 s67, s67, 7
  s_mul_i32 s66, s66, 40960
  s_add_u32 s66, s66, s67
  s_add_u32 m0, s73, 0
  s_nop 0
  buffer_load_dwordx4 v252, s[32:35], s66 offen lds
  s_addk_i32 m0, 1024
  s_add_u32 s66, s66, 10240
  buffer_load_dwordx4 v252, s[32:35], s66 offen lds
  s_addk_i32 m0, 1024
  s_add_u32 s66, s66, 10240
  buffer_load_dwordx4 v252, s[32:35], s66 offen lds
  s_addk_i32 m0, 1024
  s_add_u32 s66, s66, 10240
  buffer_load_dwordx4 v252, s[32:35], s66 offen lds
  s_cmp_ge_u32 s72, 96
  s_cbranch_scc1 Lnoin
  s_add_u32 s62, s72, 384
  s_mul_i32 s66, s62, 6554
  s_lshr_b32 s66, s66, 16
  s_mul_i32 s67, s66, 10
  s_sub_u32 s67, s62, s67
  s_lshl_b32 s67, s67, 7
  s_mul_i32 s66, s66, 40960
  s_add_u32 s66, s66, s67
  s_add_u32 m0, s73, 4096
  s_nop 0
  buffer_load_dwordx4 v252, s[32:35], s66 offen lds
  s_addk_i32 m0, 1024
  s_add_u32 s66, s66, 10240
  buffer_load_dwordx4 v252, s[32:35], s66 offen lds
  s_addk_i32 m0, 1024
  s_add_u32 s66, s66, 10240
  buffer_load_dwordx4 v252, s[32:35], s66 offen lds
  s_addk_i32 m0, 1024
  s_add_u32 s66, s66, 10240
  buffer_load_dwordx4 v252, s[32:35], s66 offen lds
Lnoin:
  s_add_u32 s51, s48, 40960
  s_add_u32 m0, s47, 5120
  s_nop 0
  buffer_load_dwordx4 v6, s[20:23], s51 offen lds
  s_addk_i32 m0, 1024
  s_nop 0
  buffer_load_dwordx4 v7, s[20:23], s51 offen lds
  s_addk_i32 m0, 1024
  s_nop 0
  buffer_load_dwordx4 v8, s[20:23], s51 offen lds
  s_addk_i32 m0, 1024
  s_nop 0
  buffer_load_dwordx4 v9, s[20:23], s51 offen lds
  s_addk_i32 m0, 1024
  s_nop 0
  buffer_load_dwordx4 v10, s[20:23], s51 offen lds
  s_add_u32 s51, s48, 81920
  s_add_u32 m0, s47, 10240
  s_nop 0
  buffer_load_dwordx4 v6, s[20:23], s51 offen lds
  s_addk_i32 m0, 1024
  s_nop 0
  buffer_load_dwordx4 v7, s[20:23], s51 offen lds
  s_addk_i32 m0, 1024
  s_nop 0
  buffer_load_dwordx4 v8, s[20:23], s51 offen lds
  s_addk_i32 m0, 1024
  s_nop 0
  buffer_load_dwordx4 v9, s[20:23], s51 offen lds
  s_addk_i32 m0, 1024
  s_nop 0
  buffer_load_dwordx4 v10, s[20:23], s51 offen lds
  s_add_u32 s51, s48, 122880
  s_add_u32 m0, s47, 15360
  s_nop 0
  buffer_load_dwordx4 v6, s[20:23], s51 offen lds
  s_addk_i32 m0, 1024
  s_nop 0
  buffer_load_dwordx4 v7, s[20:23], s51 offen lds
  s_addk_i32 m0, 1024
  s_nop 0
  buffer_load_dwordx4 v8, s[20:23], s51 offen lds
  s_addk_i32 m0, 1024
  s_nop 0
  buffer_load_dwordx4 v9, s[20:23], s51 offen lds
  s_addk_i32 m0, 1024
  s_nop 0
  buffer_load_dwordx4 v10, s[20:23], s51 offen lds
  s_waitcnt vmcnt(24)
  ds_read_b64_tr_b16 a[0:1], v14 offset:0
  ds_read_b64_tr_b16 a[2:3], v14 offset:1280
  ds_read_b64_tr_b16 a[4:5], v14 offset:32
  ds_read_b64_tr_b16 a[6:7], v14 offset:1312
  ds_read_b64_tr_b16 a[8:9], v14 offset:64
  ds_read_b64_tr_b16 a[10:11], v14 offset:1344
  ds_read_b64_tr_b16 a[12:13], v14 offset:96
  ds_read_b64_tr_b16 a[14:15], v14 offset:1376
  ds_read_b64_tr_b16 a[16:17], v14 offset:128
  ds_read_b64_tr_b16 a[18:19], v14 offset:1408
  s_waitcnt vmcnt(10)
  ds_read_b64_tr_b16 a[20:21], v14 offset:5120
  ds_read_b64_tr_b16 a[22:23], v14 offset:6400
  ds_read_b64_tr_b16 a[24:25], v14 offset:5152
  ds_read_b64_tr_b16 a[26:27], v14 offset:6432
  ds_read_b64_tr_b16 a[28:29], v14 offset:5184
  ds_read_b64_tr_b16 a[30:31], v14 offset:6464
  ds_read_b64_tr_b16 a[32:33], v14 offset:5216
  ds_read_b64_tr_b16 a[34:35], v14 offset:6496
  ds_read_b64_tr_b16 a[36:37], v14 offset:5248
  ds_read_b64_tr_b16 a[38:39], v14 offset:6528
  s_waitcnt vmcnt(5)
  ds_read_b64_tr_b16 a[40:41], v14 offset:10240
  ds_read_b64_tr_b16 a[42:43], v14 offset:11520
  ds_read_b64_tr_b16 a[44:45], v14 offset:10272
  ds_read_b64_tr_b16 a[46:47], v14 offset:11552
  ds_read_b64_tr_b16 a[48:49], v14 offset:10304
  ds_read_b64_tr_b16 a[50:51], v14 offset:11584
  ds_read_b64_tr_b16 a[52:53], v14 offset:10336
  ds_read_b64_tr_b16 a[54:55], v14 offset:11616
  ds_read_b64_tr_b16 a[56:57], v14 offset:10368
  ds_read_b64_tr_b16 a[58:59], v14 offset:11648
  s_waitcnt vmcnt(0)
  ds_read_b64_tr_b16 a[60:61], v14 offset:15360
  ds_read_b64_tr_b16 a[62:63], v14 offset:16640
  ds_read_b64_tr_b16 a[64:65], v14 offset:15392
  ds_read_b64_tr_b16 a[66:67], v14 offset:16672
  ds_read_b64_tr_b16 a[68:69], v14 offset:15424
  ds_read_b64_tr_b16 a[70:71], v14 offset:16704
  ds_read_b64_tr_b16 a[72:73], v14 offset:15456
  ds_read_b64_tr_b16 a[74:75], v14 offset:16736
  ds_read_b64_tr_b16 a[76:77], v14 offset:15488
  ds_read_b64_tr_b16 a[78:79], v14 offset:16768
  s_lshl_b32 s66, s72, 12
  s_add_u32 s66, s66, 22970368
  ds_read_b64_tr_b16 v[200:201], v250 offset:0
  ds_read_b64_tr_b16 v[202:203], v250 offset:512
  ds_read_b64_tr_b16 v[204:205], v250 offset:32
  ds_read_b64_tr_b16 v[206:207], v250 offset:544
  ds_read_b64_tr_b16 v[208:209], v250 offset:64
  ds_read_b64_tr_b16 v[210:211], v250 offset:576
  ds_read_b64_tr_b16 v[212:213], v250 offset:96
  ds_read_b64_tr_b16 v[214:215], v250 offset:608
  s_waitcnt lgkmcnt(6)
  buffer_store_dwordx4 v[200:203], v2, s[8:11], s66 offen offset:0 sc1
  s_waitcnt lgkmcnt(4)
  buffer_store_dwordx4 v[204:207], v2, s[8:11], s66 offen offset:1024 sc1
  s_waitcnt lgkmcnt(2)
  buffer_store_dwordx4 v[208:211], v2, s[8:11], s66 offen offset:2048 sc1
  s_waitcnt lgkmcnt(0)
  buffer_store_dwordx4 v[212:215], v2, s[8:11], s66 offen offset:3072 sc1
  s_cmp_ge_u32 s72, 96
  s_nop 0
  s_cbranch_scc1 Lnoout
  s_lshl_b32 s66, s72, 12
  s_add_u32 s66, s66, 24543232
  ds_read_b64_tr_b16 v[216:217], v250 offset:4096
  ds_read_b64_tr_b16 v[218:219], v250 offset:4608
  ds_read_b64_tr_b16 v[220:221], v250 offset:4128
  ds_read_b64_tr_b16 v[222:223], v250 offset:4640
  ds_read_b64_tr_b16 v[224:225], v250 offset:4160
  ds_read_b64_tr_b16 v[226:227], v250 offset:4672
  ds_read_b64_tr_b16 v[228:229], v250 offset:4192
  ds_read_b64_tr_b16 v[230:231], v250 offset:4704
  s_waitcnt lgkmcnt(6)
  buffer_store_dwordx4 v[216:219], v2, s[8:11], s66 offen offset:0 sc1
  s_waitcnt lgkmcnt(4)
  buffer_store_dwordx4 v[220:223], v2, s[8:11], s66 offen offset:1024 sc1
  s_waitcnt lgkmcnt(2)
  buffer_store_dwordx4 v[224:227], v2, s[8:11], s66 offen offset:2048 sc1
  s_waitcnt lgkmcnt(0)
  buffer_store_dwordx4 v[228:231], v2, s[8:11], s66 offen offset:3072 sc1
  s_nop 1
Lnoout:
  s_add_u32 s57, s53, 48
  s_and_b32 s57, s57, 127
  s_mul_i32 s57, s57, 15360
  s_add_u32 s57, s57, s55
  buffer_load_dword a255, v18, s[28:31], s57 offen
  s_add_u32 s57, s53, 80
  s_and_b32 s57, s57, 127
  s_mul_i32 s57, s57, 15360
  s_add_u32 s57, s57, s55
  buffer_load_dword a255, v18, s[28:31], s57 offen
  s_add_u32 s51, s48, 163840
  s_add_u32 m0, s47, 20480
  s_nop 0
  buffer_load_dwordx4 v6, s[20:23], s51 offen lds
  s_addk_i32 m0, 1024
  s_nop 0
  buffer_load_dwordx4 v7, s[20:23], s51 offen lds
  s_addk_i32 m0, 1024
  s_nop 0
  buffer_load_dwordx4 v8, s[20:23], s51 offen lds
  s_addk_i32 m0, 1024
  s_nop 0
  buffer_load_dwordx4 v9, s[20:23], s51 offen lds
  s_addk_i32 m0, 1024
  s_nop 0
  buffer_load_dwordx4 v10, s[20:23], s51 offen lds
  s_waitcnt lgkmcnt(8)
  s_add_u32 s51, s48, 0
  s_add_u32 m0, s47, 0
  s_nop 0
  buffer_load_dwordx4 v6, s[24:27], s51 offen lds
  s_addk_i32 m0, 1024
  s_nop 0
  buffer_load_dwordx4 v7, s[24:27], s51 offen lds
  s_addk_i32 m0, 1024
  s_nop 0
  buffer_load_dwordx4 v8, s[24:27], s51 offen lds
  s_addk_i32 m0, 1024
  s_nop 0
  buffer_load_dwordx4 v9, s[24:27], s51 offen lds
  s_addk_i32 m0, 1024
  s_nop 0
  buffer_load_dwordx4 v10, s[24:27], s51 offen lds
  s_add_u32 s51, s48, 40960
  s_add_u32 m0, s47, 5120
  s_nop 0
  buffer_load_dwordx4 v6, s[24:27], s51 offen lds
  s_addk_i32 m0, 1024
  s_nop 0
  buffer_load_dwordx4 v7, s[24:27], s51 offen lds
  s_addk_i32 m0, 1024
  s_nop 0
  buffer_load_dwordx4 v8, s[24:27], s51 offen lds
  s_addk_i32 m0, 1024
  s_nop 0
  buffer_load_dwordx4 v9, s[24:27], s51 offen lds
  s_addk_i32 m0, 1024
  s_nop 0
  buffer_load_dwordx4 v10, s[24:27], s51 offen lds
  s_add_u32 s51, s48, 81920
  s_add_u32 m0, s47, 10240
  s_nop 0
  buffer_load_dwordx4 v6, s[24:27], s51 offen lds
  s_addk_i32 m0, 1024
  s_nop 0
  buffer_load_dwordx4 v7, s[24:27], s51 offen lds
  s_addk_i32 m0, 1024
  s_nop 0
  buffer_load_dwordx4 v8, s[24:27], s51 offen lds
  s_addk_i32 m0, 1024
  s_nop 0
  buffer_load_dwordx4 v9, s[24:27], s51 offen lds
  s_addk_i32 m0, 1024
  s_nop 0
  buffer_load_dwordx4 v10, s[24:27], s51 offen lds
  s_add_u32 s51, s48, 122880
  s_add_u32 m0, s47, 15360
  s_nop 0
  buffer_load_dwordx4 v6, s[24:27], s51 offen lds
  s_addk_i32 m0, 1024
  s_nop 0
  buffer_load_dwordx4 v7, s[24:27], s51 offen lds
  s_addk_i32 m0, 1024
  s_nop 0
  buffer_load_dwordx4 v8, s[24:27], s51 offen lds
  s_addk_i32 m0, 1024
  s_nop 0
  buffer_load_dwordx4 v9, s[24:27], s51 offen lds
  s_addk_i32 m0, 1024
  s_nop 0
  buffer_load_dwordx4 v10, s[24:27], s51 offen lds
  s_waitcnt vmcnt(20)
  ds_read_b64_tr_b16 a[80:81], v14 offset:20480
  ds_read_b64_tr_b16 a[82:83], v14 offset:21760
  ds_read_b64_tr_b16 a[84:85], v14 offset:20512
  ds_read_b64_tr_b16 a[86:87], v14 offset:21792
  ds_read_b64_tr_b16 a[88:89], v14 offset:20544
  ds_read_b64_tr_b16 a[90:91], v14 offset:21824
  ds_read_b64_tr_b16 a[92:93], v14 offset:20576
  ds_read_b64_tr_b16 a[94:95], v14 offset:21856
  ds_read_b64_tr_b16 a[96:97], v14 offset:20608
  ds_read_b64_tr_b16 a[98:99], v14 offset:21888
  s_waitcnt vmcnt(15)
  ds_read_b64_tr_b16 a[100:101], v14 offset:0
  ds_read_b64_tr_b16 a[102:103], v14 offset:1280
  ds_read_b64_tr_b16 a[104:105], v14 offset:32
  ds_read_b64_tr_b16 a[106:107], v14 offset:1312
  ds_read_b64_tr_b16 a[108:109], v14 offset:64
  ds_read_b64_tr_b16 a[110:111], v14 offset:1344
  ds_read_b64_tr_b16 a[112:113], v14 offset:96
  ds_read_b64_tr_b16 a[114:115], v14 offset:1376
  ds_read_b64_tr_b16 a[116:117], v14 offset:128
  ds_read_b64_tr_b16 a[118:119], v14 offset:1408
  s_lshr_b32 s60, s79, 1
  s_mul_i32 s60, s60, 20480
  s_and_b32 s61, s79, 1
  s_lshl_b32 s61, s61, 6
  s_add_u32 s60, s60, s61
  s_add_u32 s60, s60, 6029312
  s_add_u32 s64, s60, 10240
  s_lshl_b32 s61, s3, 11
  s_sub_u32 s65, s60, s61
  s_add_u32 s65, s65, 8192
  s_add_u32 s66, s65, 10240
  v_lshrrev_b32 v28, 2, v0
  v_lshlrev_b32 v28, 7, v28
  v_and_b32 v21, 3, v0
  v_lshl_add_u32 v28, v21, 4, v28
  s_lshl_b32 s61, s79, 2
  v_cvt_f32_u32 v22, s61
  v_mul_f32 v22, 0x3a000000, v22
  v_cos_f32 v244, v22
  v_sin_f32 v248, v22
  v_add_f32 v22, 0x3a000000, v22
  v_cos_f32 v245, v22
  v_sin_f32 v249, v22
  v_add_f32 v22, 0x3a000000, v22
  v_cos_f32 v246, v22
  v_sin_f32 v250, v22
  v_add_f32 v22, 0x3a000000, v22
  v_cos_f32 v247, v22
  v_sin_f32 v251, v22
  v_and_b32 v20, 31, v1
  v_lshrrev_b32 v22, 5, v1
  v_lshl_add_u32 v20, v20, 1, v22
  s_mul_i32 s53, s3, 1344
  s_add_u32 s53, s53, 12288
  v_mad_u32_u24 v24, v20, 20, s53
  v_mul_u32_u24 v21, 1344, v21
  v_lshrrev_b32 v22, 2, v0
  v_lshl_add_u32 v25, v22, 4, v21
  v_add_u32 v26, 1024, v25
  v_add_u32 v27, 5120, v25
  v_cmp_gt_u32 vcc, 64, v0
  s_nop 1
  v_cndmask_b32 v26, v27, v26, vcc
  v_add_u32 v27, 6144, v25
  v_lshlrev_b32 v22, 4, v0
  v_add_u32 v22, 8704, v22
  v_min_u32 v22, 10864, v22
  v_cmp_gt_u32 vcc, 128, v0
  s_nop 1
  v_cndmask_b32 v27, v22, v27, vcc
  v_cmp_eq_u32 vcc, 63, v1
  v_lshl_add_u32 v252, v0, 1, 2
  v_sub_u32 v253, 1280, v252
  v_lshlrev_b32 v254, 1, v1
  v_sub_u32 v255, 766, v254
  v_add_u32 v254, 514, v254
  v_cndmask_b32 v255, v255, 0, vcc
  v_cndmask_b32 v30, 1.0, 0, vcc
  v_lshlrev_b32 v29, 4, v0
  s_mul_i32 s53, s3, 2560
  v_lshrrev_b32 v31, 5, v1
  v_mul_u32_u24 v31, 1280, v31
  v_bfe_u32 v16, v1, 2, 2
  v_lshl_add_u32 v31, v16, 6, v31
  v_bfe_u32 v16, v1, 4, 1
  v_lshl_add_u32 v31, v16, 5, v31
  v_and_b32 v16, 3, v1
  v_lshl_add_u32 v31, v16, 3, v31
  v_add_u32 v31, s53, v31
  s_lshl_b32 s53, s3, 10
  v_lshlrev_b32 v20, 5, v1
  v_add_u32 v21, 3072, v20
  v_add_u32 v20, s53, v20
  v_cmp_lt_u32 vcc, 31, v1
  s_nop 1
  v_cndmask_b32 v20, v20, v21, vcc
  s_mov_b32 s56, -1
  s_cmp_ge_u32 s3, 2
  s_cselect_b32 s57, -1, 0
  s_waitcnt vmcnt(0) lgkmcnt(0)
Lk2join:
  v_accvgpr_read_b32 v200, a240
  v_accvgpr_read_b32 v206, a246
  s_waitcnt lgkmcnt(10)
  v_accvgpr_read_b32 v201, a241
  s_add_u32 s51, s48, 163840
  v_accvgpr_read_b32 v207, a247
  s_add_u32 m0, s47, 20480
  v_accvgpr_read_b32 v202, a242
  buffer_load_dwordx4 v6, s[24:27], s51 offen lds
  v_accvgpr_read_b32 v208, a248
  s_addk_i32 m0, 1024
  v_accvgpr_read_b32 v203, a243
  buffer_load_dwordx4 v7, s[24:27], s51 offen lds
  v_accvgpr_read_b32 v209, a249
  v_accvgpr_read_b32 v204, a244
  s_addk_i32 m0, 1024
  v_accvgpr_read_b32 v210, a250
  buffer_load_dwordx4 v8, s[24:27], s51 offen lds
  v_lshlrev_b32 v68, 16, v200
  s_addk_i32 m0, 1024
  v_and_b32 v69, 0xffff0000, v200
  buffer_load_dwordx4 v9, s[24:27], s51 offen lds
  v_lshlrev_b32 v70, 16, v201
  s_addk_i32 m0, 1024
  v_and_b32 v71, 0xffff0000, v201
  buffer_load_dwordx4 v10, s[24:27], s51 offen lds
  v_lshlrev_b32 v72, 16, v202
  v_and_b32 v73, 0xffff0000, v202
  v_lshlrev_b32 v74, 16, v203
  s_waitcnt vmcnt(19)
  v_and_b32 v75, 0xffff0000, v203
  ds_read_b64_tr_b16 a[120:121], v14 offset:5120
  v_lshlrev_b32 v76, 16, v204
  ds_read_b64_tr_b16 a[122:123], v14 offset:6400
  v_and_b32 v77, 0xffff0000, v204
  ds_read_b64_tr_b16 a[124:125], v14 offset:5152
  v_lshlrev_b32 v84, 16, v206
  ds_read_b64_tr_b16 a[126:127], v14 offset:6432
  v_and_b32 v85, 0xffff0000, v206
  ds_read_b64_tr_b16 a[128:129], v14 offset:5184
  v_lshlrev_b32 v86, 16, v207
  ds_read_b64_tr_b16 a[130:131], v14 offset:6464
  v_and_b32 v87, 0xffff0000, v207
  v_lshlrev_b32 v88, 16, v208
  ds_read_b64_tr_b16 a[132:133], v14 offset:5216
  v_and_b32 v89, 0xffff0000, v208
  ds_read_b64_tr_b16 a[134:135], v14 offset:6496
  v_lshlrev_b32 v90, 16, v209
  ds_read_b64_tr_b16 a[136:137], v14 offset:5248
  v_and_b32 v91, 0xffff0000, v209
  ds_read_b64_tr_b16 a[138:139], v14 offset:6528
  v_lshlrev_b32 v92, 16, v210
  v_and_b32 v93, 0xffff0000, v210
  s_waitcnt vmcnt(14)
  v_pk_add_f32 v[16:17], v[68:69], v[70:71]
  ds_read_b64_tr_b16 a[140:141], v14 offset:10240
  v_pk_add_f32 v[16:17], v[16:17], v[72:73]
  v_pk_add_f32 v[16:17], v[16:17], v[74:75]
  ds_read_b64_tr_b16 a[142:143], v14 offset:11520
  v_pk_add_f32 v[16:17], v[16:17], v[76:77]
  ds_read_b64_tr_b16 a[144:145], v14 offset:10272
  v_add_f32 v16, v16, v17
  ds_read_b64_tr_b16 a[146:147], v14 offset:11552
  v_pk_add_f32 v[18:19], v[84:85], v[86:87]
  ds_read_b64_tr_b16 a[148:149], v14 offset:10304
  v_pk_add_f32 v[18:19], v[18:19], v[88:89]
  ds_read_b64_tr_b16 a[150:151], v14 offset:11584
  v_pk_add_f32 v[18:19], v[18:19], v[90:91]
  ds_read_b64_tr_b16 a[152:153], v14 offset:10336
  v_pk_add_f32 v[18:19], v[18:19], v[92:93]
  v_add_f32 v18, v18, v19
  ds_read_b64_tr_b16 a[154:155], v14 offset:11616
  v_add_f32_dpp v16, v16, v16 quad_perm:[1,0,3,2] row_mask:0xf bank_mask:0xf
  ds_read_b64_tr_b16 a[156:157], v14 offset:10368
  v_add_f32_dpp v18, v18, v18 quad_perm:[1,0,3,2] row_mask:0xf bank_mask:0xf
  ds_read_b64_tr_b16 a[158:159], v14 offset:11648
  v_add_f32_dpp v16, v16, v16 quad_perm:[2,3,0,1] row_mask:0xf bank_mask:0xf
  v_add_f32_dpp v18, v18, v18 quad_perm:[2,3,0,1] row_mask:0xf bank_mask:0xf
  s_waitcnt lgkmcnt(10)
  v_add_f32_dpp v16, v16, v16 row_half_mirror row_mask:0xf bank_mask:0xf
  s_add_u32 s51, s49, 0
  v_add_f32_dpp v18, v18, v18 row_half_mirror row_mask:0xf bank_mask:0xf
  s_add_u32 m0, s47, 0
  v_add_f32_dpp v16, v16, v16 row_mirror row_mask:0xf bank_mask:0xf
  v_add_f32_dpp v18, v18, v18 row_mirror row_mask:0xf bank_mask:0xf
  buffer_load_dwordx4 v11, s[28:31], s51 offen lds
  v_mov_b32 v17, v16
  s_addk_i32 m0, 1024
  v_mov_b32 v19, v18
  buffer_load_dwordx4 v12, s[28:31], s51 offen lds
  v_permlane16_swap_b32 v16, v17
  s_addk_i32 m0, 1024
  v_permlane16_swap_b32 v18, v19
  buffer_load_dwordx4 v13, s[28:31], s51 offen lds
  v_add_f32 v16, v16, v17
  v_add_f32 v18, v18, v19
  s_add_u32 s51, s49, 98304
  v_mov_b32 v17, v16
  v_mov_b32 v19, v18
  s_add_u32 m0, s47, 3072
  v_permlane32_swap_b32 v16, v17
  buffer_load_dwordx4 v11, s[28:31], s51 offen lds
  v_permlane32_swap_b32 v18, v19
  s_addk_i32 m0, 1024
  v_add_f32 v16, v16, v17
  buffer_load_dwordx4 v12, s[28:31], s51 offen lds
  v_add_f32 v18, v18, v19
  s_addk_i32 m0, 1024
  v_mul_f32 v22, 0x3acccccd, v16
  buffer_load_dwordx4 v13, s[28:31], s51 offen lds
  v_mul_f32 v23, 0x3acccccd, v18
  s_add_u32 s53, s44, 2
  s_mov_b32 s54, 0
  s_and_b32 s55, s2, 3
  s_lshl_b32 s55, s55, 13
  s_add_u32 s55, s55, 524288
  s_mov_b64 exec, s[56:57]
Lpoll5:
  buffer_load_dword v16, v20, s[8:11], s55 offen sc1
  s_add_u32 s54, s54, 1
  s_waitcnt vmcnt(0)
  v_subrev_u32 v16, s53, v16
  v_cmp_lt_u32 vcc, 7, v16
  s_cmp_gt_u32 s54, 200000
  s_nop 3
  s_cbranch_scc1 Lpdone6
  s_cbranch_vccz Lpdone6
  s_mov_b64 exec, vcc
  s_branch Lpoll5
Lpdone6:
  s_mov_b64 exec, -1
  buffer_load_dwordx4 v[212:215], v28, s[8:11], s60 offen sc1
  buffer_load_dwordx4 v[216:219], v28, s[8:11], s64 offen sc1
  s_cmp_lt_u32 s3, 2
  s_cbranch_scc1 Lp3a
  buffer_load_dwordx4 v[220:223], v28, s[8:11], s65 offen sc1
  buffer_load_dwordx4 v[224:227], v28, s[8:11], s66 offen sc1
Lp3a:
  s_add_u32 s51, s49, 196608
  s_add_u32 m0, s47, 6144
  s_nop 0
  buffer_load_dwordx4 v11, s[28:31], s51 offen lds
  s_addk_i32 m0, 1024
  s_nop 0
  buffer_load_dwordx4 v12, s[28:31], s51 offen lds
  s_addk_i32 m0, 1024
  s_nop 0
  buffer_load_dwordx4 v13, s[28:31], s51 offen lds
  s_waitcnt lgkmcnt(0)
  s_add_u32 s51, s49, 294912
  s_add_u32 m0, s47, 9216
  s_nop 0
  buffer_load_dwordx4 v11, s[28:31], s51 offen lds
  s_addk_i32 m0, 1024
  s_nop 0
  buffer_load_dwordx4 v12, s[28:31], s51 offen lds
  s_addk_i32 m0, 1024
  s_nop 0
  buffer_load_dwordx4 v13, s[28:31], s51 offen lds
  s_waitcnt vmcnt(20)
  ds_read_b64_tr_b16 a[160:161], v14 offset:15360
  ds_read_b64_tr_b16 a[162:163], v14 offset:16640
  ds_read_b64_tr_b16 a[164:165], v14 offset:15392
  ds_read_b64_tr_b16 a[166:167], v14 offset:16672
  ds_read_b64_tr_b16 a[168:169], v14 offset:15424
  ds_read_b64_tr_b16 a[170:171], v14 offset:16704
  ds_read_b64_tr_b16 a[172:173], v14 offset:15456
  ds_read_b64_tr_b16 a[174:175], v14 offset:16736
  ds_read_b64_tr_b16 a[176:177], v14 offset:15488
  ds_read_b64_tr_b16 a[178:179], v14 offset:16768
  s_waitcnt vmcnt(15)
  ds_read_b64_tr_b16 a[180:181], v14 offset:20480
  ds_read_b64_tr_b16 a[182:183], v14 offset:21760
  ds_read_b64_tr_b16 a[184:185], v14 offset:20512
  ds_read_b64_tr_b16 a[186:187], v14 offset:21792
  ds_read_b64_tr_b16 a[188:189], v14 offset:20544
  ds_read_b64_tr_b16 a[190:191], v14 offset:21824
  ds_read_b64_tr_b16 a[192:193], v14 offset:20576
  ds_read_b64_tr_b16 a[194:195], v14 offset:21856
  ds_read_b64_tr_b16 a[196:197], v14 offset:20608
  ds_read_b64_tr_b16 a[198:199], v14 offset:21888
  s_waitcnt vmcnt(12)
  ds_read_b64_tr_b16 a[200:201], v15 offset:0
  ds_read_b64_tr_b16 a[202:203], v15 offset:768
  ds_read_b64_tr_b16 a[204:205], v15 offset:32
  ds_read_b64_tr_b16 a[206:207], v15 offset:800
  ds_read_b64_tr_b16 a[208:209], v15 offset:64
  ds_read_b64_tr_b16 a[210:211], v15 offset:832
  s_waitcnt vmcnt(9)
  ds_read_b64_tr_b16 a[212:213], v15 offset:3072
  ds_read_b64_tr_b16 a[214:215], v15 offset:3840
  ds_read_b64_tr_b16 a[216:217], v15 offset:3104
  ds_read_b64_tr_b16 a[218:219], v15 offset:3872
  ds_read_b64_tr_b16 a[220:221], v15 offset:3136
  ds_read_b64_tr_b16 a[222:223], v15 offset:3904
  s_waitcnt vmcnt(6)
  v_lshlrev_b32 v228, 16, v212
  v_and_b32 v229, 0xffff0000, v212
  v_lshlrev_b32 v230, 16, v213
  v_and_b32 v231, 0xffff0000, v213
  v_lshlrev_b32 v232, 16, v214
  v_and_b32 v233, 0xffff0000, v214
  v_lshlrev_b32 v234, 16, v215
  v_and_b32 v235, 0xffff0000, v215
  v_lshlrev_b32 v236, 16, v216
  v_and_b32 v237, 0xffff0000, v216
  v_lshlrev_b32 v238, 16, v217
  v_and_b32 v239, 0xffff0000, v217
  v_lshlrev_b32 v240, 16, v218
  v_and_b32 v241, 0xffff0000, v218
  v_lshlrev_b32 v242, 16, v219
  v_and_b32 v243, 0xffff0000, v219
  v_pk_mul_f32 v[68:69], v[236:237], v[244:245]
  v_pk_mul_f32 v[70:71], v[240:241], v[244:245]
  v_pk_fma_f32 v[68:69], v[240:241], v[248:249], v[68:69] neg_lo:[0,1,0] neg_hi:[0,1,0]
  v_pk_fma_f32 v[70:71], v[236:237], v[248:249], v[70:71]
  v_pk_add_f32 v[72:73], v[228:229], v[68:69]
  v_pk_add_f32 v[74:75], v[232:233], v[70:71]
  v_pk_add_f32 v[76:77], v[228:229], v[68:69] neg_lo:[0,1] neg_hi:[0,1]
  v_pk_add_f32 v[78:79], v[232:233], v[70:71] neg_lo:[0,1] neg_hi:[0,1]
  v_pk_add_f32 v[68:69], v[72:73], v[78:79] neg_lo:[0,1] neg_hi:[0,1]
  v_pk_add_f32 v[70:71], v[74:75], v[76:77]
  v_pk_add_f32 v[72:73], v[72:73], v[78:79]
  v_pk_add_f32 v[76:77], v[76:77], v[74:75] neg_lo:[0,1] neg_hi:[0,1]
  v_cvt_pk_bf16_f32 v80, v68, v69
  v_cvt_pk_bf16_f32 v81, v70, v71
  v_cvt_pk_bf16_f32 v82, v72, v73
  v_cvt_pk_bf16_f32 v83, v76, v77
  ds_write_b16 v252, v80 offset:0
  ds_write_b16_d16_hi v252, v80 offset:2560
  ds_write_b16 v252, v81 offset:1280
  ds_write_b16_d16_hi v252, v81 offset:3840
  ds_write_b16 v253, v82 offset:0
  ds_write_b16_d16_hi v253, v82 offset:2560
  ds_write_b16 v253, v83 offset:1280
  ds_write_b16_d16_hi v253, v83 offset:3840
  v_pk_mul_f32 v[68:69], v[238:239], v[246:247]
  v_pk_mul_f32 v[70:71], v[242:243], v[246:247]
  v_pk_fma_f32 v[68:69], v[242:243], v[250:251], v[68:69] neg_lo:[0,1,0] neg_hi:[0,1,0]
  v_pk_fma_f32 v[70:71], v[238:239], v[250:251], v[70:71]
  v_pk_add_f32 v[72:73], v[230:231], v[68:69]
  v_pk_add_f32 v[74:75], v[234:235], v[70:71]
  v_pk_add_f32 v[76:77], v[230:231], v[68:69] neg_lo:[0,1] neg_hi:[0,1]
  v_pk_add_f32 v[78:79], v[234:235], v[70:71] neg_lo:[0,1] neg_hi:[0,1]
  v_pk_add_f32 v[68:69], v[72:73], v[78:79] neg_lo:[0,1] neg_hi:[0,1]
  v_pk_add_f32 v[70:71], v[74:75], v[76:77]
  v_pk_add_f32 v[72:73], v[72:73], v[78:79]
  v_pk_add_f32 v[76:77], v[76:77], v[74:75] neg_lo:[0,1] neg_hi:[0,1]
  v_cvt_pk_bf16_f32 v84, v68, v69
  v_cvt_pk_bf16_f32 v85, v70, v71
  v_cvt_pk_bf16_f32 v86, v72, v73
  v_cvt_pk_bf16_f32 v87, v76, v77
  ds_write_b16 v252, v84 offset:5120
  ds_write_b16_d16_hi v252, v84 offset:7680
  ds_write_b16 v252, v85 offset:6400
  ds_write_b16_d16_hi v252, v85 offset:8960
  ds_write_b16 v253, v86 offset:5120
  ds_write_b16_d16_hi v253, v86 offset:7680
  ds_write_b16 v253, v87 offset:6400
  ds_write_b16_d16_hi v253, v87 offset:8960
  s_cmp_lt_u32 s3, 2
  s_cbranch_scc1 Lp3b
  s_cmp_eq_u32 s3, 3
  s_cbranch_scc1 Lp3c
  v_lshlrev_b32 v228, 16, v220
  v_and_b32 v229, 0xffff0000, v220
  v_lshlrev_b32 v232, 16, v222
  v_and_b32 v233, 0xffff0000, v222
  v_lshlrev_b32 v236, 16, v224
  v_and_b32 v237, 0xffff0000, v224
  v_lshlrev_b32 v240, 16, v226
  v_and_b32 v241, 0xffff0000, v226
  v_pk_mul_f32 v[68:69], v[236:237], v[244:245]
  v_pk_mul_f32 v[70:71], v[240:241], v[244:245]
  v_pk_fma_f32 v[68:69], v[240:241], v[248:249], v[68:69] neg_lo:[0,1,0] neg_hi:[0,1,0]
  v_pk_fma_f32 v[70:71], v[236:237], v[248:249], v[70:71]
  v_pk_add_f32 v[72:73], v[228:229], v[68:69]
  v_pk_add_f32 v[74:75], v[232:233], v[70:71]
  v_pk_add_f32 v[76:77], v[228:229], v[68:69] neg_lo:[0,1] neg_hi:[0,1]
  v_pk_add_f32 v[78:79], v[232:233], v[70:71] neg_lo:[0,1] neg_hi:[0,1]
  v_pk_mul_f32 v[74:75], v[74:75], v[30:31] op_sel_hi:[1,0]
  v_pk_mul_f32 v[78:79], v[78:79], v[30:31] op_sel_hi:[1,0]
  v_pk_add_f32 v[68:69], v[72:73], v[78:79] neg_lo:[0,1] neg_hi:[0,1]
  v_pk_add_f32 v[70:71], v[74:75], v[76:77]
  v_pk_add_f32 v[72:73], v[72:73], v[78:79]
  v_pk_add_f32 v[76:77], v[76:77], v[74:75] neg_lo:[0,1] neg_hi:[0,1]
  v_pk_mul_f32 v[72:73], v[72:73], v[30:31] op_sel_hi:[1,0]
  v_pk_mul_f32 v[76:77], v[76:77], v[30:31] op_sel_hi:[1,0]
  v_cvt_pk_bf16_f32 v80, v68, v69
  v_cvt_pk_bf16_f32 v81, v70, v71
  v_cvt_pk_bf16_f32 v82, v72, v73
  v_cvt_pk_bf16_f32 v83, v76, v77
  ds_write_b16 v254, v80 offset:0
  ds_write_b16_d16_hi v254, v80 offset:2560
  ds_write_b16 v254, v81 offset:1280
  ds_write_b16_d16_hi v254, v81 offset:3840
  ds_write_b16 v255, v82 offset:0
  ds_write_b16_d16_hi v255, v82 offset:2560
  ds_write_b16 v255, v83 offset:1280
  ds_write_b16_d16_hi v255, v83 offset:3840
  s_branch Lp3b
Lp3c:
  v_lshlrev_b32 v230, 16, v221
  v_and_b32 v231, 0xffff0000, v221
  v_lshlrev_b32 v234, 16, v223
  v_and_b32 v235, 0xffff0000, v223
  v_lshlrev_b32 v238, 16, v225
  v_and_b32 v239, 0xffff0000, v225
  v_lshlrev_b32 v242, 16, v227
  v_and_b32 v243, 0xffff0000, v227
  v_pk_mul_f32 v[68:69], v[238:239], v[246:247]
  v_pk_mul_f32 v[70:71], v[242:243], v[246:247]
  v_pk_fma_f32 v[68:69], v[242:243], v[250:251], v[68:69] neg_lo:[0,1,0] neg_hi:[0,1,0]
  v_pk_fma_f32 v[70:71], v[238:239], v[250:251], v[70:71]
  v_pk_add_f32 v[72:73], v[230:231], v[68:69]
  v_pk_add_f32 v[74:75], v[234:235], v[70:71]
  v_pk_add_f32 v[76:77], v[230:231], v[68:69] neg_lo:[0,1] neg_hi:[0,1]
  v_pk_add_f32 v[78:79], v[234:235], v[70:71] neg_lo:[0,1] neg_hi:[0,1]
  v_pk_mul_f32 v[74:75], v[74:75], v[30:31] op_sel_hi:[1,0]
  v_pk_mul_f32 v[78:79], v[78:79], v[30:31] op_sel_hi:[1,0]
  v_pk_add_f32 v[68:69], v[72:73], v[78:79] neg_lo:[0,1] neg_hi:[0,1]
  v_pk_add_f32 v[70:71], v[74:75], v[76:77]
  v_pk_add_f32 v[72:73], v[72:73], v[78:79]
  v_pk_add_f32 v[76:77], v[76:77], v[74:75] neg_lo:[0,1] neg_hi:[0,1]
  v_pk_mul_f32 v[72:73], v[72:73], v[30:31] op_sel_hi:[1,0]
  v_pk_mul_f32 v[76:77], v[76:77], v[30:31] op_sel_hi:[1,0]
  v_cvt_pk_bf16_f32 v84, v68, v69
  v_cvt_pk_bf16_f32 v85, v70, v71
  v_cvt_pk_bf16_f32 v86, v72, v73
  v_cvt_pk_bf16_f32 v87, v76, v77
  ds_write_b16 v254, v84 offset:5120
  ds_write_b16_d16_hi v254, v84 offset:7680
  ds_write_b16 v254, v85 offset:6400
  ds_write_b16_d16_hi v254, v85 offset:8960
  ds_write_b16 v255, v86 offset:5120
  ds_write_b16_d16_hi v255, v86 offset:7680
  ds_write_b16 v255, v87 offset:6400
  ds_write_b16_d16_hi v255, v87 offset:8960
Lp3b:
  s_waitcnt lgkmcnt(0)
  s_barrier
  ds_read_b64_tr_b16 v[32:33], v31 offset:0
  ds_read_b64_tr_b16 v[34:35], v31 offset:256
  ds_read_b64_tr_b16 v[36:37], v31 offset:512
  ds_read_b64_tr_b16 v[38:39], v31 offset:768
  ds_read_b64_tr_b16 v[40:41], v31 offset:1024
  v_lshlrev_b32 v212, 16, v200
  v_and_b32 v213, 0xffff0000, v200
  v_lshlrev_b32 v214, 16, v201
  v_and_b32 v215, 0xffff0000, v201
  v_lshlrev_b32 v216, 16, v202
  v_and_b32 v217, 0xffff0000, v202
  v_lshlrev_b32 v218, 16, v203
  v_and_b32 v219, 0xffff0000, v203
  v_lshlrev_b32 v220, 16, v204
  v_and_b32 v221, 0xffff0000, v204
  v_lshlrev_b32 v222, 16, v206
  v_and_b32 v223, 0xffff0000, v206
  v_lshlrev_b32 v224, 16, v207
  v_and_b32 v225, 0xffff0000, v207
  v_lshlrev_b32 v226, 16, v208
  v_and_b32 v227, 0xffff0000, v208
  v_lshlrev_b32 v228, 16, v209
  v_and_b32 v229, 0xffff0000, v209
  v_lshlrev_b32 v230, 16, v210
  v_and_b32 v231, 0xffff0000, v210
  s_waitcnt lgkmcnt(0)
  v_mfma_f32_32x32x16_bf16 v[68:83], v[32:35], v[44:47], 0
  s_add_u32 s51, s49, 393216
  s_add_u32 m0, s47, 12288
  v_mfma_f32_32x32x16_bf16 v[84:99], v[32:35], v[56:59], 0
  buffer_load_dwordx4 v11, s[28:31], s51 offen lds
  s_addk_i32 m0, 1024
  v_mfma_f32_32x32x16_bf16 v[68:83], v[36:39], v[48:51], v[68:83]
  buffer_load_dwordx4 v12, s[28:31], s51 offen lds
  s_addk_i32 m0, 1024
  v_mfma_f32_32x32x16_bf16 v[84:99], v[36:39], v[60:63], v[84:99]
  buffer_load_dwordx4 v13, s[28:31], s51 offen lds
  s_add_u32 s51, s49, 491520
  v_mfma_f32_32x32x16_bf16 v[68:83], v[40:43], v[52:55], v[68:83]
  s_add_u32 m0, s47, 15360
  s_nop 0
  buffer_load_dwordx4 v11, s[28:31], s51 offen lds
  v_mfma_f32_32x32x16_bf16 v[84:99], v[40:43], v[64:67], v[84:99]
  s_addk_i32 m0, 1024
  s_nop 0
  buffer_load_dwordx4 v12, s[28:31], s51 offen lds
  v_sub_f32 v212, v212, v22
  v_sub_f32 v222, v222, v23
  v_sub_f32 v213, v213, v22
  v_sub_f32 v223, v223, v23
  v_sub_f32 v214, v214, v22
  v_sub_f32 v224, v224, v23
  v_sub_f32 v215, v215, v22
  v_sub_f32 v225, v225, v23
  v_sub_f32 v216, v216, v22
  v_sub_f32 v226, v226, v23
  v_sub_f32 v217, v217, v22
  v_sub_f32 v227, v227, v23
  v_sub_f32 v218, v218, v22
  v_sub_f32 v228, v228, v23
  v_sub_f32 v219, v219, v22
  v_sub_f32 v229, v229, v23
  v_sub_f32 v220, v220, v22
  v_sub_f32 v230, v230, v23
  v_sub_f32 v221, v221, v22
  v_sub_f32 v231, v231, v23
  v_pk_mul_f32 v[188:189], v[68:69], v[100:101]
  v_pk_mul_f32 v[190:191], v[84:85], v[100:101]
  v_pk_fma_f32 v[188:189], v[84:85], v[116:117], v[188:189] neg_lo:[0,1,0] neg_hi:[0,1,0]
  v_pk_fma_f32 v[190:191], v[68:69], v[116:117], v[190:191]
  v_cvt_pk_bf16_f32 v132, v188, v189
  v_cvt_pk_bf16_f32 v134, v190, v191
  v_pk_mul_f32 v[192:193], v[70:71], v[102:103]
  v_pk_mul_f32 v[194:195], v[86:87], v[102:103]
  v_pk_fma_f32 v[192:193], v[86:87], v[118:119], v[192:193] neg_lo:[0,1,0] neg_hi:[0,1,0]
  v_pk_fma_f32 v[194:195], v[70:71], v[118:119], v[194:195]
  v_cvt_pk_bf16_f32 v133, v192, v193
  v_cvt_pk_bf16_f32 v135, v194, v195
  v_pk_mul_f32 v[188:189], v[72:73], v[104:105]
  v_pk_mul_f32 v[190:191], v[88:89], v[104:105]
  v_pk_fma_f32 v[188:189], v[88:89], v[120:121], v[188:189] neg_lo:[0,1,0] neg_hi:[0,1,0]
  v_pk_fma_f32 v[190:191], v[72:73], v[120:121], v[190:191]
  v_cvt_pk_bf16_f32 v136, v188, v189
  v_cvt_pk_bf16_f32 v138, v190, v191
  v_pk_mul_f32 v[192:193], v[74:75], v[106:107]
  v_pk_mul_f32 v[194:195], v[90:91], v[106:107]
  v_pk_fma_f32 v[192:193], v[90:91], v[122:123], v[192:193] neg_lo:[0,1,0] neg_hi:[0,1,0]
  v_pk_fma_f32 v[194:195], v[74:75], v[122:123], v[194:195]
  v_cvt_pk_bf16_f32 v137, v192, v193
  v_cvt_pk_bf16_f32 v139, v194, v195
  v_pk_mul_f32 v[188:189], v[76:77], v[108:109]
  v_pk_mul_f32 v[190:191], v[92:93], v[108:109]
  v_pk_fma_f32 v[188:189], v[92:93], v[124:125], v[188:189] neg_lo:[0,1,0] neg_hi:[0,1,0]
  v_pk_fma_f32 v[190:191], v[76:77], v[124:125], v[190:191]
  v_cvt_pk_bf16_f32 v140, v188, v189
  v_cvt_pk_bf16_f32 v142, v190, v191
  v_pk_mul_f32 v[192:193], v[78:79], v[110:111]
  v_pk_mul_f32 v[194:195], v[94:95], v[110:111]
  v_pk_fma_f32 v[192:193], v[94:95], v[126:127], v[192:193] neg_lo:[0,1,0] neg_hi:[0,1,0]
  v_pk_fma_f32 v[194:195], v[78:79], v[126:127], v[194:195]
  v_cvt_pk_bf16_f32 v141, v192, v193
  v_cvt_pk_bf16_f32 v143, v194, v195
  v_pk_mul_f32 v[188:189], v[80:81], v[112:113]
  v_pk_mul_f32 v[190:191], v[96:97], v[112:113]
  v_pk_fma_f32 v[188:189], v[96:97], v[128:129], v[188:189] neg_lo:[0,1,0] neg_hi:[0,1,0]
  v_pk_fma_f32 v[190:191], v[80:81], v[128:129], v[190:191]
  v_cvt_pk_bf16_f32 v144, v188, v189
  v_cvt_pk_bf16_f32 v146, v190, v191
  v_pk_mul_f32 v[192:193], v[82:83], v[114:115]
  v_pk_mul_f32 v[194:195], v[98:99], v[114:115]
  v_pk_fma_f32 v[192:193], v[98:99], v[130:131], v[192:193] neg_lo:[0,1,0] neg_hi:[0,1,0]
  v_pk_fma_f32 v[194:195], v[82:83], v[130:131], v[194:195]
  v_cvt_pk_bf16_f32 v145, v192, v193
  v_cvt_pk_bf16_f32 v147, v194, v195
  v_mfma_f32_32x32x16_bf16 v[68:83], v[132:135], v[154:157], 0
  s_addk_i32 m0, 1024
  s_nop 0
  buffer_load_dwordx4 v13, s[28:31], s51 offen lds
  v_mfma_f32_32x32x16_bf16 v[84:99], v[132:135], v[152:155], 0
  s_add_u32 s51, s49, 589824
  s_add_u32 m0, s47, 18432
  v_mfma_f32_32x32x16_bf16 v[68:83], v[136:139], v[164:167], v[68:83]
  buffer_load_dwordx4 v11, s[28:31], s51 offen lds
  s_addk_i32 m0, 1024
  v_mfma_f32_32x32x16_bf16 v[84:99], v[136:139], v[162:165], v[84:99]
  buffer_load_dwordx4 v12, s[28:31], s51 offen lds
  s_addk_i32 m0, 1024
  v_mfma_f32_32x32x16_bf16 v[68:83], v[140:143], v[174:177], v[68:83]
  buffer_load_dwordx4 v13, s[28:31], s51 offen lds
  s_add_u32 s51, s49, 688128
  v_mfma_f32_32x32x16_bf16 v[84:99], v[140:143], v[172:175], v[84:99]
  s_add_u32 m0, s47, 21504
  s_nop 0
  buffer_load_dwordx4 v11, s[28:31], s51 offen lds
  v_mfma_f32_32x32x16_bf16 v[68:83], v[144:147], v[184:187], v[68:83]
  s_addk_i32 m0, 1024
  s_nop 0
  buffer_load_dwordx4 v12, s[28:31], s51 offen lds
  v_mfma_f32_32x32x16_bf16 v[84:99], v[144:147], v[182:185], v[84:99]
  s_addk_i32 m0, 1024
  s_nop 0
  buffer_load_dwordx4 v13, s[28:31], s51 offen lds
  v_mov_b32 v232, v22
  v_mov_b32 v236, v23
  v_mov_b32 v235, 0
  v_mov_b32 v239, 0
  s_lshl_b32 s53, s3, 4
  v_mov_b32 v22, s53
  s_mul_i32 s60, s79, 10368
  s_add_u32 s60, s60, 8650752
  v_add_u32 v23, 5376, v24
  v_pk_add_f32 v[212:213], v[212:213], v[68:69]
  v_pk_add_f32 v[222:223], v[222:223], v[84:85]
  v_pk_mul_f32 v[16:17], v[212:213], v[212:213]
  v_pk_mul_f32 v[18:19], v[222:223], v[222:223]
  v_pk_add_f32 v[214:215], v[214:215], v[70:71]
  v_pk_add_f32 v[224:225], v[224:225], v[86:87]
  v_pk_fma_f32 v[16:17], v[214:215], v[214:215], v[16:17]
  v_pk_fma_f32 v[18:19], v[224:225], v[224:225], v[18:19]
  v_pk_add_f32 v[216:217], v[216:217], v[72:73]
  v_pk_add_f32 v[226:227], v[226:227], v[88:89]
  v_pk_fma_f32 v[16:17], v[216:217], v[216:217], v[16:17]
  v_pk_fma_f32 v[18:19], v[226:227], v[226:227], v[18:19]
  v_pk_add_f32 v[218:219], v[218:219], v[74:75]
  v_pk_add_f32 v[228:229], v[228:229], v[90:91]
  v_pk_fma_f32 v[16:17], v[218:219], v[218:219], v[16:17]
  v_pk_fma_f32 v[18:19], v[228:229], v[228:229], v[18:19]
  v_pk_add_f32 v[220:221], v[220:221], v[76:77]
  v_pk_add_f32 v[230:231], v[230:231], v[92:93]
  v_pk_fma_f32 v[16:17], v[220:221], v[220:221], v[16:17]
  v_pk_fma_f32 v[18:19], v[230:231], v[230:231], v[18:19]
  v_add_f32 v16, v16, v17
  v_add_f32 v18, v18, v19
  s_nop 0
  v_add_f32_dpp v16, v16, v16 quad_perm:[1,0,3,2] row_mask:0xf bank_mask:0xf
  v_add_f32_dpp v18, v18, v18 quad_perm:[1,0,3,2] row_mask:0xf bank_mask:0xf
  s_nop 0
  v_add_f32_dpp v16, v16, v16 quad_perm:[2,3,0,1] row_mask:0xf bank_mask:0xf
  v_add_f32_dpp v18, v18, v18 quad_perm:[2,3,0,1] row_mask:0xf bank_mask:0xf
  s_nop 0
  v_add_f32_dpp v16, v16, v16 row_half_mirror row_mask:0xf bank_mask:0xf
  v_add_f32_dpp v18, v18, v18 row_half_mirror row_mask:0xf bank_mask:0xf
  s_nop 0
  v_add_f32_dpp v16, v16, v16 row_mirror row_mask:0xf bank_mask:0xf
  v_add_f32_dpp v18, v18, v18 row_mirror row_mask:0xf bank_mask:0xf
  v_mov_b32 v17, v16
  v_mov_b32 v19, v18
  s_nop 0
  v_permlane16_swap_b32 v16, v17
  v_permlane16_swap_b32 v18, v19
  v_add_f32 v16, v16, v17
  v_add_f32 v18, v18, v19
  v_mov_b32 v17, v16
  v_mov_b32 v19, v18
  s_nop 0
  v_permlane32_swap_b32 v16, v17
  v_permlane32_swap_b32 v18, v19
  v_add_f32 v16, v16, v17
  v_add_f32 v18, v18, v19
  v_mul_f32 v17, 0x3acccccd, v16
  v_add_f32 v68, 0x3727c5ac, v17
  v_mul_f32 v19, 0x3acccccd, v18
  v_add_f32 v84, 0x3727c5ac, v19
  v_rsq_f32 v16, v68
  v_rsq_f32 v18, v84
  v_mov_b32 v240, -1
  v_mov_b32 v241, -1
  v_mov_b32 v242, -1
  v_mov_b32 v243, -1
  s_lshl_b32 s57, s45, 2
  s_add_u32 s57, s57, s3
  s_mul_i32 s56, s57, 20480
  s_mul_i32 s58, s46, 2560
  s_add_u32 s56, s56, s58
  s_add_u32 s56, s56, 13926400
  buffer_store_dwordx4 v[240:243], v2, s[8:11], s56 offen offset:0 sc1
  buffer_store_dwordx4 v[240:243], v2, s[8:11], s56 offen offset:1024 sc1
  buffer_store_dwordx4 v[240:243], v2, s[8:11], s56 offen offset:1536 sc1
  s_lshl_b32 s57, s57, 10
  s_lshl_b32 s58, s46, 7
  s_add_u32 s57, s57, s58
  s_add_u32 s57, s57, 16547840
  v_cmp_gt_u32 vcc, 8, v1
  v_mov_b32 v28, 0x40000000
  s_nop 0
  v_cndmask_b32 v28, v28, v2, vcc
  buffer_store_dwordx4 v[240:243], v28, s[8:11], s57 offen offset:0 sc1
  v_pk_mul_f32 v[212:213], v[212:213], v[16:17] op_sel_hi:[1,0]
  v_pk_mul_f32 v[222:223], v[222:223], v[18:19] op_sel_hi:[1,0]
  v_cvt_pk_bf16_f32 v200, v212, v213
  v_cvt_pk_bf16_f32 v206, v222, v223
  v_pk_mul_f32 v[214:215], v[214:215], v[16:17] op_sel_hi:[1,0]
  v_pk_mul_f32 v[224:225], v[224:225], v[18:19] op_sel_hi:[1,0]
  v_cvt_pk_bf16_f32 v201, v214, v215
  v_cvt_pk_bf16_f32 v207, v224, v225
  ds_write2_b32 v24, v200, v201 offset0:0 offset1:1
  ds_write2_b32 v23, v206, v207 offset0:0 offset1:1
  v_pk_mul_f32 v[216:217], v[216:217], v[16:17] op_sel_hi:[1,0]
  v_pk_mul_f32 v[226:227], v[226:227], v[18:19] op_sel_hi:[1,0]
  v_cvt_pk_bf16_f32 v202, v216, v217
  v_cvt_pk_bf16_f32 v208, v226, v227
  v_pk_mul_f32 v[218:219], v[218:219], v[16:17] op_sel_hi:[1,0]
  v_pk_mul_f32 v[228:229], v[228:229], v[18:19] op_sel_hi:[1,0]
  v_cvt_pk_bf16_f32 v203, v218, v219
  v_cvt_pk_bf16_f32 v209, v228, v229
  ds_write2_b32 v24, v202, v203 offset0:2 offset1:3
  ds_write2_b32 v23, v208, v209 offset0:2 offset1:3
  v_pk_mul_f32 v[220:221], v[220:221], v[16:17] op_sel_hi:[1,0]
  v_pk_mul_f32 v[230:231], v[230:231], v[18:19] op_sel_hi:[1,0]
  v_cvt_pk_bf16_f32 v204, v220, v221
  v_cvt_pk_bf16_f32 v210, v230, v231
  ds_write_b32 v24, v204 offset:16
  ds_write_b32 v23, v210 offset:16
  v_mul_f32 v233, v68, v16
  v_mul_f32 v69, v16, v16
  v_fmaak_f32 v234, v69, v17, 0x3727c5ac
  v_mul_f32 v237, v84, v18
  v_mul_f32 v85, v18, v18
  v_fmaak_f32 v238, v85, v19, 0x3727c5ac
  s_mov_b64 exec, 1
  ds_write_b128 v22, v[232:235] offset:23040
  ds_write_b128 v22, v[236:239] offset:23104
  s_mov_b64 exec, -1
  s_add_u32 s53, s60, 4096
  s_add_u32 s54, s60, 8192
  v_cmp_gt_u32 vcc, 136, v0
  v_mov_b32 v20, 0x40000000
  s_nop 0
  v_cndmask_b32 v20, v20, v29, vcc
  s_waitcnt lgkmcnt(0)
  s_barrier
  ds_read_b128 v[68:71], v25 offset:12288
  ds_read_b128 v[72:75], v26 offset:12288
  ds_read_b128 v[76:79], v27 offset:12288
  s_waitcnt lgkmcnt(2)
  buffer_store_dwordx4 v[68:71], v29, s[8:11], s60 offen sc1
  s_waitcnt lgkmcnt(1)
  buffer_store_dwordx4 v[72:75], v29, s[8:11], s53 offen sc1
  s_waitcnt lgkmcnt(0)
  buffer_store_dwordx4 v[76:79], v20, s[8:11], s54 offen sc1
  v_lshrrev_b32 v18, 2, v4
  v_mul_u32_u24 v18, 10368, v18
  s_waitcnt vmcnt(22)
  v_and_b32 v17, 3, v4
  ds_read_b64_tr_b16 a[224:225], v15 offset:6144
  v_lshl_add_u32 v18, v17, 4, v18
  ds_read_b64_tr_b16 a[226:227], v15 offset:6912
  v_lshl_add_u32 v19, v5, 6, v18
  ds_read_b64_tr_b16 a[228:229], v15 offset:6176
  s_and_b32 s60, s45, 15
  ds_read_b64_tr_b16 a[230:231], v15 offset:6944
  s_mul_i32 s60, s60, 165888
  s_lshr_b32 s61, s45, 4
  ds_read_b64_tr_b16 a[232:233], v15 offset:6208
  s_mul_i32 s62, s61, 5120
  ds_read_b64_tr_b16 a[234:235], v15 offset:6976
  s_add_u32 s62, s62, s60
  s_add_u32 s62, s62, 8650752
  s_waitcnt vmcnt(19)
  s_mul_i32 s63, s3, 1280
  ds_read_b64_tr_b16 a[236:237], v15 offset:9216
  s_add_u32 s63, s63, s62
  s_add_u32 s68, s63, 4096
  ds_read_b64_tr_b16 a[238:239], v15 offset:9984
  s_add_u32 s69, s63, 8192
  ds_read_b64_tr_b16 a[240:241], v15 offset:9248
  s_lshl_b32 s57, s3, 3
  ds_read_b64_tr_b16 a[242:243], v15 offset:10016
  s_lshr_b32 s57, 0xe4934e39, s57
  ds_read_b64_tr_b16 a[244:245], v15 offset:9280
  s_bfe_u32 s55, s57, 0x20000
  ds_read_b64_tr_b16 a[246:247], v15 offset:10048
  s_mul_i32 s56, s55, 41472
  v_add_u32 v212, s56, v19
  s_mul_i32 s74, s55, 15360
  s_waitcnt lgkmcnt(15)
  s_sub_u32 s55, s3, s55
  s_add_u32 s51, s49, 786432
  s_sub_u32 s55, s55, 1
  s_add_u32 m0, s47, 0
  s_and_b32 s55, s55, 3
  buffer_load_dwordx4 v11, s[28:31], s51 offen lds
  s_mul_i32 s55, s55, 5120
  s_addk_i32 m0, 1024
  s_add_u32 s74, s74, s55
  s_bfe_u32 s55, s57, 0x20002
  buffer_load_dwordx4 v12, s[28:31], s51 offen lds
  s_mul_i32 s56, s55, 41472
  s_addk_i32 m0, 1024
  v_add_u32 v213, s56, v19
  buffer_load_dwordx4 v13, s[28:31], s51 offen lds
  s_mul_i32 s75, s55, 15360
  s_sub_u32 s55, s3, s55
  s_add_u32 s51, s49, 884736
  s_sub_u32 s55, s55, 1
  s_add_u32 m0, s47, 3072
  s_and_b32 s55, s55, 3
  s_mul_i32 s55, s55, 5120
  buffer_load_dwordx4 v11, s[28:31], s51 offen lds
  s_add_u32 s75, s75, s55
  s_addk_i32 m0, 1024
  s_bfe_u32 s55, s57, 0x20004
  buffer_load_dwordx4 v12, s[28:31], s51 offen lds
  s_mul_i32 s56, s55, 41472
  s_addk_i32 m0, 1024
  v_add_u32 v214, s56, v19
  buffer_load_dwordx4 v13, s[28:31], s51 offen lds
  s_mul_i32 s76, s55, 15360
  s_sub_u32 s55, s3, s55
  s_sub_u32 s55, s55, 1
  s_waitcnt vmcnt(22)
  s_and_b32 s55, s55, 3
  ds_read_b64_tr_b16 a[248:249], v15 offset:12288
  s_mul_i32 s55, s55, 5120
  ds_read_b64_tr_b16 a[250:251], v15 offset:13056
  s_add_u32 s76, s76, s55
  ds_read_b64_tr_b16 a[252:253], v15 offset:12320
  s_bfe_u32 s55, s57, 0x20006
  ds_read_b64_tr_b16 a[254:255], v15 offset:13088
  s_mul_i32 s56, s55, 41472
  v_add_u32 v215, s56, v19
  ds_read_b64_tr_b16 v[216:217], v15 offset:12352
  s_mul_i32 s77, s55, 15360
  ds_read_b64_tr_b16 v[218:219], v15 offset:13120
  s_mul_i32 s72, s3, 41472
  s_add_u32 s72, s72, s62
  s_waitcnt vmcnt(19)
  s_mul_i32 s73, s61, 5056
  ds_read_b64_tr_b16 v[220:221], v15 offset:15360
  s_sub_u32 s73, s72, s73
  s_add_u32 s73, s73, 10240
  ds_read_b64_tr_b16 v[222:223], v15 offset:16128
  v_mov_b32 v192, v18
  ds_read_b64_tr_b16 v[224:225], v15 offset:15392
  s_and_b32 s55, s45, 15
  ds_read_b64_tr_b16 v[226:227], v15 offset:16160
  s_lshl_b32 s55, s55, 11
  ds_read_b64_tr_b16 v[228:229], v15 offset:15424
  v_lshlrev_b32 v108, 7, v4
  ds_read_b64_tr_b16 v[230:231], v15 offset:16192
  v_add_u32 v108, s55, v108
  s_waitcnt vmcnt(6)
  s_barrier
  s_cmp_lg_u32 s3, 0
  s_cbranch_scc1 Lsig7
  s_add_u32 s53, s44, 3
  s_lshl_b32 s54, s2, 7
  v_mov_b32 v16, s53
  v_lshlrev_b32 v17, 15, v1
  s_mov_b64 exec, 1
  buffer_store_dword v16, v17, s[8:11], s54 offen sc1
  s_mov_b64 exec, 1
  s_cmp_lt_u32 s2, 160
  s_cbranch_scc1 Lsig7x
  v_mov_b32 v17, 1
  buffer_atomic_add v17, off, s[40:43], 0 offset:128 sc1
  s_nop 0
Lsig7x:
  s_mov_b64 exec, -1
Lsig7:
  s_waitcnt lgkmcnt(12)
  s_add_u32 s51, s49, 983040
  s_add_u32 m0, s47, 6144
  s_nop 0
  buffer_load_dwordx4 v11, s[28:31], s51 offen lds
  s_addk_i32 m0, 1024
  s_nop 0
  buffer_load_dwordx4 v12, s[28:31], s51 offen lds
  s_addk_i32 m0, 1024
  s_nop 0
  buffer_load_dwordx4 v13, s[28:31], s51 offen lds
  s_add_u32 s51, s49, 1081344
  s_add_u32 m0, s47, 9216
  s_nop 0
  buffer_load_dwordx4 v11, s[28:31], s51 offen lds
  s_addk_i32 m0, 1024
  s_nop 0
  buffer_load_dwordx4 v12, s[28:31], s51 offen lds
  s_addk_i32 m0, 1024
  s_nop 0
  buffer_load_dwordx4 v13, s[28:31], s51 offen lds
  s_waitcnt lgkmcnt(0)
  s_add_u32 s51, s49, 1179648
  s_add_u32 m0, s47, 12288
  s_nop 0
  buffer_load_dwordx4 v11, s[28:31], s51 offen lds
  s_addk_i32 m0, 1024
  s_nop 0
  buffer_load_dwordx4 v12, s[28:31], s51 offen lds
  s_addk_i32 m0, 1024
  s_nop 0
  buffer_load_dwordx4 v13, s[28:31], s51 offen lds
  buffer_load_dword v109, v108, s[8:11], 0 offen sc1
  s_add_u32 s51, s49, 1277952
  s_add_u32 m0, s47, 15360
  s_nop 0
  buffer_load_dwordx4 v11, s[28:31], s51 offen lds
  s_addk_i32 m0, 1024
  s_nop 0
  buffer_load_dwordx4 v12, s[28:31], s51 offen lds
  s_addk_i32 m0, 1024
  s_nop 0
  buffer_load_dwordx4 v13, s[28:31], s51 offen lds
  s_waitcnt vmcnt(29)
  ds_read_b64_tr_b16 v[232:233], v15 offset:18432
  ds_read_b64_tr_b16 v[234:235], v15 offset:19200
  ds_read_b64_tr_b16 v[236:237], v15 offset:18464
  ds_read_b64_tr_b16 v[238:239], v15 offset:19232
  ds_read_b64_tr_b16 v[240:241], v15 offset:18496
  ds_read_b64_tr_b16 v[242:243], v15 offset:19264
  s_waitcnt vmcnt(26)
  ds_read_b64_tr_b16 v[244:245], v15 offset:21504
  ds_read_b64_tr_b16 v[246:247], v15 offset:22272
  ds_read_b64_tr_b16 v[248:249], v15 offset:21536
  ds_read_b64_tr_b16 v[250:251], v15 offset:22304
  ds_read_b64_tr_b16 v[252:253], v15 offset:21568
  ds_read_b64_tr_b16 v[254:255], v15 offset:22336
  s_waitcnt vmcnt(3)
  s_add_u32 s53, s44, 3
  v_subrev_u32 v109, s53, v109
  v_cmp_lt_u32 vcc, 7, v109
  s_cbranch_vccnz Lretry8
Lresume9:
  buffer_load_dwordx4 v[112:115], v212, s[8:11], s63 offen offset:0 sc1
  buffer_load_dwordx4 v[116:119], v212, s[8:11], s63 offen offset:256 sc1
  buffer_load_dwordx4 v[120:123], v212, s[8:11], s63 offen offset:512 sc1
  buffer_load_dwordx4 v[124:127], v212, s[8:11], s63 offen offset:768 sc1
  buffer_load_dwordx4 v[128:131], v212, s[8:11], s63 offen offset:1024 sc1
  buffer_load_dwordx4 v[132:135], v213, s[8:11], s63 offen offset:0 sc1
  buffer_load_dwordx4 v[136:139], v213, s[8:11], s63 offen offset:256 sc1
  v_mov_b32 v32, 0x3f803f80
  v_mov_b32 v33, 0x3f803f80
  v_mov_b32 v34, 0x3f803f80
  v_mov_b32 v35, 0x3f803f80
  s_waitcnt lgkmcnt(15)
  s_nop 0
  v_mfma_f32_16x16x32_bf16 v[20:23], a[200:203], v[32:35], 0
  v_mfma_f32_16x16x32_bf16 v[24:27], a[204:207], v[32:35], 0
  v_mfma_f32_16x16x32_bf16 v[28:31], a[208:211], v[32:35], 0
  s_waitcnt lgkmcnt(15)
  v_mfma_f32_16x16x32_bf16 v[20:23], a[212:215], v[32:35], v[20:23]
  v_mfma_f32_16x16x32_bf16 v[24:27], a[216:219], v[32:35], v[24:27]
  v_mfma_f32_16x16x32_bf16 v[28:31], a[220:223], v[32:35], v[28:31]
  s_waitcnt lgkmcnt(15)
  v_mfma_f32_16x16x32_bf16 v[20:23], a[224:227], v[32:35], v[20:23]
  v_mfma_f32_16x16x32_bf16 v[24:27], a[228:231], v[32:35], v[24:27]
  v_mfma_f32_16x16x32_bf16 v[28:31], a[232:235], v[32:35], v[28:31]
  s_waitcnt lgkmcnt(15)
  v_mfma_f32_16x16x32_bf16 v[20:23], a[236:239], v[32:35], v[20:23]
  v_mfma_f32_16x16x32_bf16 v[24:27], a[240:243], v[32:35], v[24:27]
  v_mfma_f32_16x16x32_bf16 v[28:31], a[244:247], v[32:35], v[28:31]
  s_waitcnt lgkmcnt(15)
  v_mfma_f32_16x16x32_bf16 v[20:23], a[248:251], v[32:35], v[20:23]
  v_mfma_f32_16x16x32_bf16 v[24:27], a[252:255], v[32:35], v[24:27]
  v_mfma_f32_16x16x32_bf16 v[28:31], v[216:219], v[32:35], v[28:31]
  s_waitcnt lgkmcnt(12)
  v_mfma_f32_16x16x32_bf16 v[20:23], v[220:223], v[32:35], v[20:23]
  v_mfma_f32_16x16x32_bf16 v[24:27], v[224:227], v[32:35], v[24:27]
  v_mfma_f32_16x16x32_bf16 v[28:31], v[228:231], v[32:35], v[28:31]
  s_waitcnt lgkmcnt(6)
  v_mfma_f32_16x16x32_bf16 v[20:23], v[232:235], v[32:35], v[20:23]
  v_mfma_f32_16x16x32_bf16 v[24:27], v[236:239], v[32:35], v[24:27]
  v_mfma_f32_16x16x32_bf16 v[28:31], v[240:243], v[32:35], v[28:31]
  s_waitcnt lgkmcnt(0)
  v_mfma_f32_16x16x32_bf16 v[20:23], v[244:247], v[32:35], v[20:23]
  v_mfma_f32_16x16x32_bf16 v[24:27], v[248:251], v[32:35], v[24:27]
  v_mfma_f32_16x16x32_bf16 v[28:31], v[252:255], v[32:35], v[28:31]
  s_waitcnt vmcnt(6)
  v_mfma_f32_16x16x32_bf16 v[52:55], a[0:3], v[112:115], 0
  v_mfma_f32_16x16x32_bf16 v[56:59], a[4:7], v[112:115], 0
  v_mfma_f32_16x16x32_bf16 v[60:63], a[8:11], v[112:115], 0
  buffer_load_dwordx4 v[140:143], v213, s[8:11], s63 offen offset:512 sc1
  v_mfma_f32_16x16x32_bf16 v[64:67], a[12:15], v[112:115], 0
  v_mfma_f32_16x16x32_bf16 v[68:71], a[16:19], v[112:115], 0
  s_waitcnt vmcnt(6)
  v_mfma_f32_16x16x32_bf16 v[52:55], a[20:23], v[116:119], v[52:55]
  v_mfma_f32_16x16x32_bf16 v[56:59], a[24:27], v[116:119], v[56:59]
  v_mfma_f32_16x16x32_bf16 v[60:63], a[28:31], v[116:119], v[60:63]
  buffer_load_dwordx4 v[144:147], v213, s[8:11], s63 offen offset:768 sc1
  v_mfma_f32_16x16x32_bf16 v[64:67], a[32:35], v[116:119], v[64:67]
  v_mfma_f32_16x16x32_bf16 v[68:71], a[36:39], v[116:119], v[68:71]
  s_waitcnt vmcnt(6)
  v_mfma_f32_16x16x32_bf16 v[52:55], a[40:43], v[120:123], v[52:55]
  v_mfma_f32_16x16x32_bf16 v[56:59], a[44:47], v[120:123], v[56:59]
  v_mfma_f32_16x16x32_bf16 v[60:63], a[48:51], v[120:123], v[60:63]
  buffer_load_dwordx4 v[148:151], v213, s[8:11], s63 offen offset:1024 sc1
  v_mfma_f32_16x16x32_bf16 v[64:67], a[52:55], v[120:123], v[64:67]
  v_mfma_f32_16x16x32_bf16 v[68:71], a[56:59], v[120:123], v[68:71]
  s_waitcnt vmcnt(6)
  v_mfma_f32_16x16x32_bf16 v[52:55], a[60:63], v[124:127], v[52:55]
  v_mfma_f32_16x16x32_bf16 v[56:59], a[64:67], v[124:127], v[56:59]
  v_mfma_f32_16x16x32_bf16 v[60:63], a[68:71], v[124:127], v[60:63]
  buffer_load_dwordx4 v[152:155], v214, s[8:11], s63 offen offset:0 sc1
  v_mfma_f32_16x16x32_bf16 v[64:67], a[72:75], v[124:127], v[64:67]
  v_mfma_f32_16x16x32_bf16 v[68:71], a[76:79], v[124:127], v[68:71]
  s_waitcnt vmcnt(6)
  v_mfma_f32_16x16x32_bf16 v[52:55], a[80:83], v[128:131], v[52:55]
  v_mfma_f32_16x16x32_bf16 v[56:59], a[84:87], v[128:131], v[56:59]
  v_mfma_f32_16x16x32_bf16 v[60:63], a[88:91], v[128:131], v[60:63]
  buffer_load_dwordx4 v[156:159], v214, s[8:11], s63 offen offset:256 sc1
  v_mfma_f32_16x16x32_bf16 v[64:67], a[92:95], v[128:131], v[64:67]
  v_mfma_f32_16x16x32_bf16 v[68:71], a[96:99], v[128:131], v[68:71]
  s_waitcnt vmcnt(6)
  v_mfma_f32_16x16x32_bf16 v[72:75], a[0:3], v[132:135], 0
  v_mfma_f32_16x16x32_bf16 v[76:79], a[4:7], v[132:135], 0
  v_mfma_f32_16x16x32_bf16 v[80:83], a[8:11], v[132:135], 0
  buffer_load_dwordx4 v[160:163], v214, s[8:11], s63 offen offset:512 sc1
  v_mfma_f32_16x16x32_bf16 v[84:87], a[12:15], v[132:135], 0
  v_mfma_f32_16x16x32_bf16 v[88:91], a[16:19], v[132:135], 0
  s_waitcnt vmcnt(6)
  v_mfma_f32_16x16x32_bf16 v[72:75], a[20:23], v[136:139], v[72:75]
  v_add_u32 v16, s74, v2
  ds_write_b128 v16, v[52:55] offset:0
  v_mfma_f32_16x16x32_bf16 v[76:79], a[24:27], v[136:139], v[76:79]
  ds_write_b128 v16, v[56:59] offset:1024
  v_mfma_f32_16x16x32_bf16 v[80:83], a[28:31], v[136:139], v[80:83]
  ds_write_b128 v16, v[60:63] offset:2048
  v_mfma_f32_16x16x32_bf16 v[84:87], a[32:35], v[136:139], v[84:87]
  buffer_load_dwordx4 v[164:167], v214, s[8:11], s63 offen offset:768 sc1
  v_mfma_f32_16x16x32_bf16 v[88:91], a[36:39], v[136:139], v[88:91]
  s_waitcnt vmcnt(6)
  v_mfma_f32_16x16x32_bf16 v[72:75], a[40:43], v[140:143], v[72:75]
  v_mfma_f32_16x16x32_bf16 v[76:79], a[44:47], v[140:143], v[76:79]
  ds_write_b128 v16, v[64:67] offset:3072
  ds_write_b128 v16, v[68:71] offset:4096
  v_mfma_f32_16x16x32_bf16 v[80:83], a[48:51], v[140:143], v[80:83]
  v_mfma_f32_16x16x32_bf16 v[84:87], a[52:55], v[140:143], v[84:87]
  buffer_load_dwordx4 v[168:171], v214, s[8:11], s63 offen offset:1024 sc1
  v_mfma_f32_16x16x32_bf16 v[88:91], a[56:59], v[140:143], v[88:91]
  s_waitcnt vmcnt(6)
  v_mfma_f32_16x16x32_bf16 v[72:75], a[60:63], v[144:147], v[72:75]
  buffer_load_dwordx4 v[172:175], v215, s[8:11], s63 offen offset:0 sc1
  v_mfma_f32_16x16x32_bf16 v[76:79], a[64:67], v[144:147], v[76:79]
  s_mov_b32 s65, s46
  s_and_b32 s53, s65, 1
  s_mul_i32 s54, s65, 80
  v_mfma_f32_16x16x32_bf16 v[80:83], a[68:71], v[144:147], v[80:83]
  s_lshl_b32 s66, s53, 4
  s_add_u32 s66, s66, s54
  s_xor_b32 s53, s53, 1
  s_mul_i32 s67, s53, 64
  v_mfma_f32_16x16x32_bf16 v[84:87], a[72:75], v[144:147], v[84:87]
  s_add_u32 s67, s67, s54
  s_lshl_b32 s64, s45, 2
  s_add_u32 s64, s64, s3
  s_mul_i32 s60, s64, 20480
  v_mfma_f32_16x16x32_bf16 v[88:91], a[76:79], v[144:147], v[88:91]
  v_and_b32 v18, 1, v5
  v_lshlrev_b32 v18, 1, v18
  v_lshrrev_b32 v17, 1, v5
  s_waitcnt vmcnt(6)
  v_mfma_f32_16x16x32_bf16 v[72:75], a[80:83], v[148:151], v[72:75]
  v_or_b32 v18, v18, v17
  v_lshlrev_b32 v18, 8, v18
  v_lshl_add_u32 v18, v4, 4, v18
  v_lshrrev_b32 v19, 1, v5
  v_mfma_f32_16x16x32_bf16 v[76:79], a[84:87], v[148:151], v[76:79]
  v_lshlrev_b32 v19, 8, v19
  v_lshl_add_u32 v19, v4, 4, v19
  v_and_b32 v17, 1, v5
  v_lshl_add_u32 v19, v17, 3, v19
  v_mfma_f32_16x16x32_bf16 v[80:83], a[88:91], v[148:151], v[80:83]
  s_lshl_b32 s61, s66, 5
  s_add_u32 s61, s61, s60
  s_add_u32 s61, s61, 11304960
  s_lshl_b32 s62, s67, 5
  v_mfma_f32_16x16x32_bf16 v[84:87], a[92:95], v[148:151], v[84:87]
  s_add_u32 s62, s62, s60
  s_add_u32 s62, s62, 11304960
  v_add_u32 v17, s77, v2
  v_mfma_f32_16x16x32_bf16 v[88:91], a[96:99], v[148:151], v[88:91]
  buffer_load_dwordx4 v[176:179], v215, s[8:11], s63 offen offset:256 sc1
  s_waitcnt vmcnt(6)
  v_mfma_f32_16x16x32_bf16 v[92:95], a[0:3], v[152:155], 0
  v_mfma_f32_16x16x32_bf16 v[96:99], a[4:7], v[152:155], 0
  v_mfma_f32_16x16x32_bf16 v[100:103], a[8:11], v[152:155], 0
  buffer_load_dwordx4 v[180:183], v215, s[8:11], s63 offen offset:512 sc1
  v_mfma_f32_16x16x32_bf16 v[104:107], a[12:15], v[152:155], 0
  v_mfma_f32_16x16x32_bf16 v[108:111], a[16:19], v[152:155], 0
  s_waitcnt vmcnt(6)
  v_mfma_f32_16x16x32_bf16 v[92:95], a[20:23], v[156:159], v[92:95]
  v_add_u32 v16, s75, v2
  ds_write_b128 v16, v[72:75] offset:0
  ds_write_b128 v16, v[76:79] offset:1024
  v_mfma_f32_16x16x32_bf16 v[96:99], a[24:27], v[156:159], v[96:99]
  ds_write_b128 v16, v[80:83] offset:2048
  buffer_load_dwordx4 v[184:187], v215, s[8:11], s63 offen offset:768 sc1
  v_mfma_f32_16x16x32_bf16 v[100:103], a[28:31], v[156:159], v[100:103]
  ds_write_b128 v16, v[84:87] offset:3072
  v_mfma_f32_16x16x32_bf16 v[104:107], a[32:35], v[156:159], v[104:107]
  ds_write_b128 v16, v[88:91] offset:4096
  v_mfma_f32_16x16x32_bf16 v[108:111], a[36:39], v[156:159], v[108:111]
  buffer_load_dwordx4 v[188:191], v215, s[8:11], s63 offen offset:1024 sc1
  s_waitcnt vmcnt(7)
  v_mfma_f32_16x16x32_bf16 v[92:95], a[40:43], v[160:163], v[92:95]
  buffer_load_dwordx4 v[204:207], v192, s[8:11], s73 offen sc1
  v_mfma_f32_16x16x32_bf16 v[96:99], a[44:47], v[160:163], v[96:99]
  v_mov_b32 v196, -1
  v_mfma_f32_16x16x32_bf16 v[100:103], a[48:51], v[160:163], v[100:103]
  v_mov_b32 v197, -1
  v_mov_b32 v198, -1
  v_mov_b32 v199, -1
  v_mfma_f32_16x16x32_bf16 v[104:107], a[52:55], v[160:163], v[104:107]
  s_lshl_b32 s70, s45, 2
  s_add_u32 s70, s70, s3
  s_mul_i32 s70, s70, 49152
  s_mul_i32 s71, s46, 6144
  v_mfma_f32_16x16x32_bf16 v[108:111], a[56:59], v[160:163], v[108:111]
  s_add_u32 s70, s70, s71
  s_add_u32 s70, s70, 16678912
  s_add_u32 s71, s70, 4096
  s_waitcnt vmcnt(7)
  v_mfma_f32_16x16x32_bf16 v[92:95], a[60:63], v[164:167], v[92:95]
  v_mfma_f32_16x16x32_bf16 v[96:99], a[64:67], v[164:167], v[96:99]
  v_mfma_f32_16x16x32_bf16 v[100:103], a[68:71], v[164:167], v[100:103]
  buffer_store_dwordx4 v[196:199], v2, s[8:11], s70 offen offset:0 sc1
  v_mfma_f32_16x16x32_bf16 v[104:107], a[72:75], v[164:167], v[104:107]
  v_mfma_f32_16x16x32_bf16 v[108:111], a[76:79], v[164:167], v[108:111]
  s_waitcnt vmcnt(7)
  v_mfma_f32_16x16x32_bf16 v[92:95], a[80:83], v[168:171], v[92:95]
  v_mfma_f32_16x16x32_bf16 v[96:99], a[84:87], v[168:171], v[96:99]
  v_mfma_f32_16x16x32_bf16 v[100:103], a[88:91], v[168:171], v[100:103]
  buffer_store_dwordx4 v[196:199], v2, s[8:11], s70 offen offset:1024 sc1
  v_mfma_f32_16x16x32_bf16 v[104:107], a[92:95], v[168:171], v[104:107]
  v_mfma_f32_16x16x32_bf16 v[108:111], a[96:99], v[168:171], v[108:111]
  s_waitcnt vmcnt(7)
  v_mfma_f32_16x16x32_bf16 v[32:35], a[0:3], v[172:175], 0
  buffer_store_dwordx4 v[196:199], v2, s[8:11], s70 offen offset:2048 sc1
  s_add_u32 s51, s49, 1376256
  s_add_u32 m0, s47, 18432
  s_nop 0
  buffer_load_dwordx4 v11, s[28:31], s51 offen lds
  v_mfma_f32_16x16x32_bf16 v[36:39], a[4:7], v[172:175], 0
  s_addk_i32 m0, 1024
  s_nop 0
  buffer_load_dwordx4 v12, s[28:31], s51 offen lds
  v_mfma_f32_16x16x32_bf16 v[40:43], a[8:11], v[172:175], 0
  s_addk_i32 m0, 1024
  s_nop 0
  buffer_load_dwordx4 v13, s[28:31], s51 offen lds
  s_add_u32 s51, s49, 1474560
  s_add_u32 m0, s47, 21504
  v_mfma_f32_16x16x32_bf16 v[44:47], a[12:15], v[172:175], 0
  buffer_load_dwordx4 v11, s[28:31], s51 offen lds
  s_addk_i32 m0, 1024
  s_nop 0
  buffer_load_dwordx4 v12, s[28:31], s51 offen lds
  v_mfma_f32_16x16x32_bf16 v[48:51], a[16:19], v[172:175], 0
  s_addk_i32 m0, 1024
  s_nop 0
  buffer_load_dwordx4 v13, s[28:31], s51 offen lds
  s_waitcnt vmcnt(13)
  v_mfma_f32_16x16x32_bf16 v[32:35], a[20:23], v[176:179], v[32:35]
  v_add_u32 v16, s76, v2
  ds_write_b128 v16, v[92:95] offset:0
  v_mfma_f32_16x16x32_bf16 v[36:39], a[24:27], v[176:179], v[36:39]
  ds_write_b128 v16, v[96:99] offset:1024
  v_mfma_f32_16x16x32_bf16 v[40:43], a[28:31], v[176:179], v[40:43]
  ds_write_b128 v16, v[100:103] offset:2048
  v_mfma_f32_16x16x32_bf16 v[44:47], a[32:35], v[176:179], v[44:47]
  buffer_store_dwordx4 v[196:199], v2, s[8:11], s70 offen offset:3072 sc1
  v_mfma_f32_16x16x32_bf16 v[48:51], a[36:39], v[176:179], v[48:51]
  s_waitcnt vmcnt(13)
  v_mfma_f32_16x16x32_bf16 v[32:35], a[40:43], v[180:183], v[32:35]
  v_mfma_f32_16x16x32_bf16 v[36:39], a[44:47], v[180:183], v[36:39]
  ds_write_b128 v16, v[104:107] offset:3072
  ds_write_b128 v16, v[108:111] offset:4096
  v_mfma_f32_16x16x32_bf16 v[40:43], a[48:51], v[180:183], v[40:43]
  v_mfma_f32_16x16x32_bf16 v[44:47], a[52:55], v[180:183], v[44:47]
  buffer_store_dwordx4 v[196:199], v2, s[8:11], s71 offen offset:0 sc1
  v_mfma_f32_16x16x32_bf16 v[48:51], a[56:59], v[180:183], v[48:51]
  s_waitcnt vmcnt(13)
  v_mfma_f32_16x16x32_bf16 v[32:35], a[60:63], v[184:187], v[32:35]
  buffer_store_dwordx4 v[196:199], v2, s[8:11], s71 offen offset:1024 sc1
  v_mfma_f32_16x16x32_bf16 v[36:39], a[64:67], v[184:187], v[36:39]
  s_waitcnt vmcnt(12)
  v_mfma_f32_16x16x32_bf16 v[40:43], a[68:71], v[184:187], v[40:43]
  v_rsq_f32 v211, v206
  v_mfma_f32_16x16x32_bf16 v[44:47], a[72:75], v[184:187], v[44:47]
  s_nop 0
  v_mul_f32 v210, v206, v211
  v_mul_f32 v208, 0xc0135761, v211
  v_mfma_f32_16x16x32_bf16 v[48:51], a[76:79], v[184:187], v[48:51]
  v_mul_f32 v209, v211, v211
  v_mul_f32 v209, v209, v211
  v_mul_f32 v209, 0xbdd2d3e8, v209
  s_waitcnt lgkmcnt(0)
  s_barrier
  ds_read_b128 v[92:95], v17 offset:0
  ds_read_b128 v[96:99], v17 offset:1024
  ds_read_b128 v[100:103], v17 offset:2048
  ds_read_b128 v[104:107], v17 offset:3072
  ds_read_b128 v[108:111], v17 offset:4096
  ds_read_b128 v[52:55], v17 offset:5120
  ds_read_b128 v[56:59], v17 offset:6144
  ds_read_b128 v[60:63], v17 offset:7168
  ds_read_b128 v[64:67], v17 offset:8192
  ds_read_b128 v[68:71], v17 offset:9216
  ds_read_b128 v[72:75], v17 offset:10240
  ds_read_b128 v[76:79], v17 offset:11264
  ds_read_b128 v[80:83], v17 offset:12288
  ds_read_b128 v[84:87], v17 offset:13312
  ds_read_b128 v[88:91], v17 offset:14336
  s_waitcnt vmcnt(13)
  v_mfma_f32_16x16x32_bf16 v[32:35], a[80:83], v[188:191], v[32:35]
  v_mfma_f32_16x16x32_bf16 v[36:39], a[84:87], v[188:191], v[36:39]
  v_mfma_f32_16x16x32_bf16 v[40:43], a[88:91], v[188:191], v[40:43]
  v_mfma_f32_16x16x32_bf16 v[44:47], a[92:95], v[188:191], v[44:47]
  v_mfma_f32_16x16x32_bf16 v[48:51], a[96:99], v[188:191], v[48:51]
  s_waitcnt lgkmcnt(5)
  v_pk_add_f32 v[92:93], v[92:93], v[52:53]
  v_pk_add_f32 v[94:95], v[94:95], v[54:55]
  v_pk_add_f32 v[96:97], v[96:97], v[56:57]
  v_pk_add_f32 v[98:99], v[98:99], v[58:59]
  s_waitcnt lgkmcnt(0)
  v_pk_add_f32 v[32:33], v[32:33], v[72:73]
  v_pk_add_f32 v[34:35], v[34:35], v[74:75]
  v_pk_add_f32 v[36:37], v[36:37], v[76:77]
  v_pk_add_f32 v[38:39], v[38:39], v[78:79]
  v_pk_add_f32 v[32:33], v[32:33], v[92:93]
  v_pk_add_f32 v[34:35], v[34:35], v[94:95]
  v_pk_add_f32 v[36:37], v[36:37], v[96:97]
  v_pk_add_f32 v[38:39], v[38:39], v[98:99]
  v_pk_mul_f32 v[92:93], v[32:33], v[32:33]
  v_pk_mul_f32 v[94:95], v[34:35], v[34:35]
  v_pk_mul_f32 v[96:97], v[36:37], v[36:37]
  v_pk_mul_f32 v[98:99], v[38:39], v[38:39]
  v_pk_fma_f32 v[92:93], v[92:93], v[208:209], v[208:209] op_sel:[0,1,0] op_sel_hi:[1,1,0]
  v_pk_fma_f32 v[94:95], v[94:95], v[208:209], v[208:209] op_sel:[0,1,0] op_sel_hi:[1,1,0]
  v_pk_fma_f32 v[96:97], v[96:97], v[208:209], v[208:209] op_sel:[0,1,0] op_sel_hi:[1,1,0]
  v_pk_fma_f32 v[98:99], v[98:99], v[208:209], v[208:209] op_sel:[0,1,0] op_sel_hi:[1,1,0]
  v_pk_mul_f32 v[92:93], v[92:93], v[32:33]
  v_pk_mul_f32 v[94:95], v[94:95], v[34:35]
  v_pk_mul_f32 v[96:97], v[96:97], v[36:37]
  v_pk_mul_f32 v[98:99], v[98:99], v[38:39]
  v_exp_f32 v92, v92
  v_exp_f32 v93, v93
  v_exp_f32 v94, v94
  v_exp_f32 v95, v95
  v_exp_f32 v96, v96
  v_exp_f32 v97, v97
  v_exp_f32 v98, v98
  v_exp_f32 v99, v99
  v_pk_fma_f32 v[92:93], v[92:93], v[210:211], v[210:211] op_sel_hi:[1,0,0]
  v_pk_fma_f32 v[94:95], v[94:95], v[210:211], v[210:211] op_sel_hi:[1,0,0]
  v_pk_fma_f32 v[96:97], v[96:97], v[210:211], v[210:211] op_sel_hi:[1,0,0]
  v_pk_fma_f32 v[98:99], v[98:99], v[210:211], v[210:211] op_sel_hi:[1,0,0]
  v_rcp_f32 v92, v92
  v_rcp_f32 v93, v93
  v_rcp_f32 v94, v94
  v_rcp_f32 v95, v95
  v_rcp_f32 v96, v96
  v_rcp_f32 v97, v97
  v_rcp_f32 v98, v98
  v_rcp_f32 v99, v99
  v_pk_mul_f32 v[32:33], v[32:33], v[92:93]
  v_pk_mul_f32 v[34:35], v[34:35], v[94:95]
  v_pk_mul_f32 v[36:37], v[36:37], v[96:97]
  v_pk_mul_f32 v[38:39], v[38:39], v[98:99]
  v_cvt_pk_bf16_f32 v132, v32, v33
  v_cvt_pk_bf16_f32 v133, v34, v35
  v_cvt_pk_bf16_f32 v134, v36, v37
  v_cvt_pk_bf16_f32 v135, v38, v39
  s_nop 0
  v_permlane16_swap_b32 v132, v134
  v_permlane16_swap_b32 v133, v135
  buffer_store_dwordx4 v[132:135], v18, s[8:11], s61 offen offset:0 sc1
  v_pk_add_f32 v[100:101], v[100:101], v[60:61]
  v_pk_add_f32 v[102:103], v[102:103], v[62:63]
  v_pk_add_f32 v[104:105], v[104:105], v[64:65]
  v_pk_add_f32 v[106:107], v[106:107], v[66:67]
  v_pk_add_f32 v[40:41], v[40:41], v[80:81]
  v_pk_add_f32 v[42:43], v[42:43], v[82:83]
  v_pk_add_f32 v[44:45], v[44:45], v[84:85]
  v_pk_add_f32 v[46:47], v[46:47], v[86:87]
  v_pk_add_f32 v[40:41], v[40:41], v[100:101]
  v_pk_add_f32 v[42:43], v[42:43], v[102:103]
  v_pk_add_f32 v[44:45], v[44:45], v[104:105]
  v_pk_add_f32 v[46:47], v[46:47], v[106:107]
  v_pk_mul_f32 v[100:101], v[40:41], v[40:41]
  v_pk_mul_f32 v[102:103], v[42:43], v[42:43]
  v_pk_mul_f32 v[104:105], v[44:45], v[44:45]
  v_pk_mul_f32 v[106:107], v[46:47], v[46:47]
  v_pk_fma_f32 v[100:101], v[100:101], v[208:209], v[208:209] op_sel:[0,1,0] op_sel_hi:[1,1,0]
  v_pk_fma_f32 v[102:103], v[102:103], v[208:209], v[208:209] op_sel:[0,1,0] op_sel_hi:[1,1,0]
  v_pk_fma_f32 v[104:105], v[104:105], v[208:209], v[208:209] op_sel:[0,1,0] op_sel_hi:[1,1,0]
  v_pk_fma_f32 v[106:107], v[106:107], v[208:209], v[208:209] op_sel:[0,1,0] op_sel_hi:[1,1,0]
  v_pk_mul_f32 v[100:101], v[100:101], v[40:41]
  v_pk_mul_f32 v[102:103], v[102:103], v[42:43]
  v_pk_mul_f32 v[104:105], v[104:105], v[44:45]
  v_pk_mul_f32 v[106:107], v[106:107], v[46:47]
  v_exp_f32 v100, v100
  v_exp_f32 v101, v101
  v_exp_f32 v102, v102
  v_exp_f32 v103, v103
  v_exp_f32 v104, v104
  v_exp_f32 v105, v105
  v_exp_f32 v106, v106
  v_exp_f32 v107, v107
  v_pk_fma_f32 v[100:101], v[100:101], v[210:211], v[210:211] op_sel_hi:[1,0,0]
  v_pk_fma_f32 v[102:103], v[102:103], v[210:211], v[210:211] op_sel_hi:[1,0,0]
  v_pk_fma_f32 v[104:105], v[104:105], v[210:211], v[210:211] op_sel_hi:[1,0,0]
  v_pk_fma_f32 v[106:107], v[106:107], v[210:211], v[210:211] op_sel_hi:[1,0,0]
  v_rcp_f32 v100, v100
  v_rcp_f32 v101, v101
  v_rcp_f32 v102, v102
  v_rcp_f32 v103, v103
  v_rcp_f32 v104, v104
  v_rcp_f32 v105, v105
  v_rcp_f32 v106, v106
  v_rcp_f32 v107, v107
  v_pk_mul_f32 v[40:41], v[40:41], v[100:101]
  v_pk_mul_f32 v[42:43], v[42:43], v[102:103]
  v_pk_mul_f32 v[44:45], v[44:45], v[104:105]
  v_pk_mul_f32 v[46:47], v[46:47], v[106:107]
  v_cvt_pk_bf16_f32 v136, v40, v41
  v_cvt_pk_bf16_f32 v137, v42, v43
  v_cvt_pk_bf16_f32 v138, v44, v45
  v_cvt_pk_bf16_f32 v139, v46, v47
  s_nop 0
  v_permlane16_swap_b32 v136, v138
  v_permlane16_swap_b32 v137, v139
  buffer_store_dwordx4 v[136:139], v18, s[8:11], s61 offen offset:1024 sc1
  v_pk_add_f32 v[108:109], v[108:109], v[68:69]
  v_pk_add_f32 v[110:111], v[110:111], v[70:71]
  v_pk_add_f32 v[48:49], v[48:49], v[88:89]
  v_pk_add_f32 v[50:51], v[50:51], v[90:91]
  v_pk_add_f32 v[48:49], v[48:49], v[108:109]
  v_pk_add_f32 v[50:51], v[50:51], v[110:111]
  v_pk_mul_f32 v[108:109], v[48:49], v[48:49]
  v_pk_mul_f32 v[110:111], v[50:51], v[50:51]
  v_pk_fma_f32 v[108:109], v[108:109], v[208:209], v[208:209] op_sel:[0,1,0] op_sel_hi:[1,1,0]
  v_pk_fma_f32 v[110:111], v[110:111], v[208:209], v[208:209] op_sel:[0,1,0] op_sel_hi:[1,1,0]
  v_pk_mul_f32 v[108:109], v[108:109], v[48:49]
  v_pk_mul_f32 v[110:111], v[110:111], v[50:51]
  v_exp_f32 v108, v108
  v_exp_f32 v109, v109
  v_exp_f32 v110, v110
  v_exp_f32 v111, v111
  v_pk_fma_f32 v[108:109], v[108:109], v[210:211], v[210:211] op_sel_hi:[1,0,0]
  v_pk_fma_f32 v[110:111], v[110:111], v[210:211], v[210:211] op_sel_hi:[1,0,0]
  v_rcp_f32 v108, v108
  v_rcp_f32 v109, v109
  v_rcp_f32 v110, v110
  v_rcp_f32 v111, v111
  v_pk_mul_f32 v[48:49], v[48:49], v[108:109]
  v_pk_mul_f32 v[50:51], v[50:51], v[110:111]
  v_cvt_pk_bf16_f32 v140, v48, v49
  v_cvt_pk_bf16_f32 v141, v50, v51
  buffer_store_dwordx2 v[140:141], v19, s[8:11], s62 offen sc1
  v_and_b32 v16, 1, v5
  v_lshlrev_b32 v16, 1, v16
  v_lshrrev_b32 v17, 1, v5
  v_or_b32 v16, v16, v17
  v_lshl_add_u32 v16, v16, 6, v192
  v_lshrrev_b32 v17, 1, v5
  v_lshl_add_u32 v0, v17, 6, v192
  v_and_b32 v17, 1, v5
  v_lshl_add_u32 v17, v17, 3, v0
  s_lshl_b32 s54, s66, 3
  s_add_u32 s54, s54, s72
  s_lshl_b32 s55, s67, 3
  s_add_u32 s55, s55, s72
  buffer_load_dwordx4 v[192:195], v16, s[8:11], s54 offen sc1
  buffer_load_dwordx4 v[196:199], v16, s[8:11], s54 offen offset:256 sc1
  buffer_load_dwordx2 v[200:201], v17, s[8:11], s55 offen sc1
  s_lshr_b32 s60, s3, 1
  s_add_u32 s60, s60, 1
  s_waitcnt vmcnt(55)
  s_sub_u32 s61, 0, s60
  ds_read_b64_tr_b16 a[0:1], v15 offset:0
  s_bitcmp1_b32 s3, 0
  s_cselect_b32 s60, s60, s61
  ds_read_b64_tr_b16 a[2:3], v15 offset:768
  v_add_u32 v18, s60, v4
  ds_read_b64_tr_b16 a[4:5], v15 offset:32
  v_ashrrev_i32 v19, 4, v18
  ds_read_b64_tr_b16 a[6:7], v15 offset:800
  v_mul_i32_i24 v19, 20480, v19
  ds_read_b64_tr_b16 a[8:9], v15 offset:64
  v_and_b32 v18, 15, v18
  v_lshl_add_u32 v19, v18, 4, v19
  ds_read_b64_tr_b16 a[10:11], v15 offset:832
  v_lshl_add_u32 v19, v5, 8, v19
  s_mul_i32 s61, s3, 5120
  s_waitcnt vmcnt(52)
  s_mul_i32 s62, s45, 81920
  ds_read_b64_tr_b16 a[12:13], v15 offset:3072
  s_add_u32 s61, s61, s62
  v_add_u32 v19, s61, v19
  ds_read_b64_tr_b16 a[14:15], v15 offset:3840
  s_mov_b32 s63, 0
  ds_read_b64_tr_b16 a[16:17], v15 offset:3104
  s_add_u32 s68, s63, 4096
  ds_read_b64_tr_b16 a[18:19], v15 offset:3872
  s_add_u32 s69, s63, 8192
  s_lshl_b32 s57, s3, 3
  ds_read_b64_tr_b16 a[20:21], v15 offset:3136
  s_lshr_b32 s57, 0xe4934e39, s57
  ds_read_b64_tr_b16 a[22:23], v15 offset:3904
  s_bfe_u32 s55, s57, 0x20000
  s_mul_i32 s56, s55, 20480
  v_add_u32 v212, s56, v19
  s_waitcnt vmcnt(49)
  s_mul_i32 s74, s55, 15360
  ds_read_b64_tr_b16 a[24:25], v15 offset:6144
  s_sub_u32 s55, s3, s55
  ds_read_b64_tr_b16 a[26:27], v15 offset:6912
  s_sub_u32 s55, s55, 1
  ds_read_b64_tr_b16 a[28:29], v15 offset:6176
  s_and_b32 s55, s55, 3
  s_mul_i32 s55, s55, 5120
  ds_read_b64_tr_b16 a[30:31], v15 offset:6944
  s_add_u32 s74, s74, s55
  ds_read_b64_tr_b16 a[32:33], v15 offset:6208
  s_bfe_u32 s55, s57, 0x20002
  ds_read_b64_tr_b16 a[34:35], v15 offset:6976
  s_mul_i32 s56, s55, 20480
  v_add_u32 v213, s56, v19
  s_mul_i32 s75, s55, 15360
  s_waitcnt vmcnt(46)
  s_sub_u32 s55, s3, s55
  ds_read_b64_tr_b16 a[36:37], v15 offset:9216
  s_sub_u32 s55, s55, 1
  s_and_b32 s55, s55, 3
  ds_read_b64_tr_b16 a[38:39], v15 offset:9984
  s_mul_i32 s55, s55, 5120
  ds_read_b64_tr_b16 a[40:41], v15 offset:9248
  s_add_u32 s75, s75, s55
  ds_read_b64_tr_b16 a[42:43], v15 offset:10016
  s_bfe_u32 s55, s57, 0x20004
  ds_read_b64_tr_b16 a[44:45], v15 offset:9280
  s_mul_i32 s56, s55, 20480
  v_add_u32 v214, s56, v19
  ds_read_b64_tr_b16 a[46:47], v15 offset:10048
  s_mul_i32 s76, s55, 15360
  s_sub_u32 s55, s3, s55
  s_waitcnt vmcnt(43)
  s_sub_u32 s55, s55, 1
  s_and_b32 s55, s55, 3
  ds_read_b64_tr_b16 a[48:49], v15 offset:12288
  s_mul_i32 s55, s55, 5120
  ds_read_b64_tr_b16 a[50:51], v15 offset:13056
  s_add_u32 s76, s76, s55
  ds_read_b64_tr_b16 a[52:53], v15 offset:12320
  s_bfe_u32 s55, s57, 0x20006
  ds_read_b64_tr_b16 a[54:55], v15 offset:13088
  s_mul_i32 s56, s55, 20480
  v_add_u32 v215, s56, v19
  ds_read_b64_tr_b16 a[56:57], v15 offset:12352
  s_mul_i32 s77, s55, 15360
  ds_read_b64_tr_b16 a[58:59], v15 offset:13120
  s_and_b32 s53, s46, 1
  s_mul_i32 s55, s46, 5
  s_add_u32 s54, s55, s53
  s_waitcnt vmcnt(39)
  v_lshl_add_u32 v6, s54, 10, v2
  ds_read_b64_tr_b16 a[60:61], v15 offset:15360
  s_xor_b32 s53, s53, 1
  ds_read_b64_tr_b16 a[62:63], v15 offset:16128
  s_lshl_b32 s53, s53, 2
  s_add_u32 s54, s55, s53
  ds_read_b64_tr_b16 a[64:65], v15 offset:15392
  v_lshl_add_u32 v7, s54, 10, v2
  ds_read_b64_tr_b16 a[66:67], v15 offset:16160
  v_add_u32 v8, s47, v2
  ds_read_b64_tr_b16 a[68:69], v15 offset:15424
  s_mul_i32 s50, s3, 491520
  ds_read_b64_tr_b16 a[70:71], v15 offset:16192
  v_and_b32 v109, 1, v1
  s_lshl_b32 s55, s3, 1
  v_add_u32 v109, s55, v109
  s_waitcnt vmcnt(12)
  v_mov_b32 v110, s45
  ds_read_b64_tr_b16 a[72:73], v15 offset:18432
  s_add_u32 s55, s45, 1
  s_min_u32 s55, s55, 31
  ds_read_b64_tr_b16 a[74:75], v15 offset:19200
  s_sub_u32 s56, s45, 1
  ds_read_b64_tr_b16 a[76:77], v15 offset:18464
  s_max_i32 s56, s56, 0
  ds_read_b64_tr_b16 a[78:79], v15 offset:19232
  s_bitcmp1_b32 s3, 0
  s_cselect_b32 s55, s55, s56
  ds_read_b64_tr_b16 a[80:81], v15 offset:18496
  v_mov_b32 v111, s55
  ds_read_b64_tr_b16 a[82:83], v15 offset:19264
  v_cmp_lt_u32 vcc, 1, v1
  s_nop 1
  v_cndmask_b32 v110, v110, v111, vcc
  s_waitcnt vmcnt(9)
  v_lshrrev_b32 v108, 3, v110
  v_lshlrev_b32 v108, 1, v108
  ds_read_b64_tr_b16 a[84:85], v15 offset:21504
  v_and_b32 v110, 7, v110
  ds_read_b64_tr_b16 a[86:87], v15 offset:22272
  v_lshl_add_u32 v108, v110, 3, v108
  ds_read_b64_tr_b16 a[88:89], v15 offset:21536
  v_lshrrev_b32 v110, 2, v109
  v_add_u32 v108, v108, v110
  ds_read_b64_tr_b16 a[90:91], v15 offset:22304
  v_and_b32 v109, 3, v109
  ds_read_b64_tr_b16 a[92:93], v15 offset:21568
  v_lshl_add_u32 v108, v109, 6, v108
  ds_read_b64_tr_b16 a[94:95], v15 offset:22336
  v_lshlrev_b32 v108, 7, v108
  s_waitcnt vmcnt(3)
  s_barrier
  s_cmp_lg_u32 s3, 0
  s_cbranch_scc1 Lsig10
  s_add_u32 s53, s44, 4
  s_lshl_b32 s54, s2, 7
  v_mov_b32 v16, s53
  v_lshlrev_b32 v17, 15, v1
  s_mov_b64 exec, 1
  buffer_store_dword v16, v17, s[8:11], s54 offen sc1
  s_mov_b64 exec, 1
  s_mov_b64 exec, -1
Lsig10:
  s_waitcnt lgkmcnt(0)
  s_add_u32 s51, s49, 1572864
  s_add_u32 m0, s47, 6144
  s_nop 0
  buffer_load_dwordx4 v11, s[28:31], s51 offen lds
  s_addk_i32 m0, 1024
  s_nop 0
  buffer_load_dwordx4 v12, s[28:31], s51 offen lds
  s_addk_i32 m0, 1024
  s_nop 0
  buffer_load_dwordx4 v13, s[28:31], s51 offen lds
  s_add_u32 s51, s49, 1671168
  s_add_u32 m0, s47, 9216
  s_nop 0
  buffer_load_dwordx4 v11, s[28:31], s51 offen lds
  s_addk_i32 m0, 1024
  s_nop 0
  buffer_load_dwordx4 v12, s[28:31], s51 offen lds
  s_addk_i32 m0, 1024
  s_nop 0
  buffer_load_dwordx4 v13, s[28:31], s51 offen lds
  s_add_u32 s51, s49, 1769472
  s_add_u32 m0, s47, 12288
  s_nop 0
  buffer_load_dwordx4 v11, s[28:31], s51 offen lds
  s_addk_i32 m0, 1024
  s_nop 0
  buffer_load_dwordx4 v12, s[28:31], s51 offen lds
  s_addk_i32 m0, 1024
  s_nop 0
  buffer_load_dwordx4 v13, s[28:31], s51 offen lds
  buffer_load_dword v109, v108, s[8:11], 0 offen sc1
  s_add_u32 s51, s49, 1867776
  s_add_u32 m0, s47, 15360
  s_nop 0
  buffer_load_dwordx4 v11, s[28:31], s51 offen lds
  s_addk_i32 m0, 1024
  s_nop 0
  buffer_load_dwordx4 v12, s[28:31], s51 offen lds
  s_addk_i32 m0, 1024
  s_nop 0
  buffer_load_dwordx4 v13, s[28:31], s51 offen lds
  buffer_load_dword v0, off, s[40:43], 0 offset:128 sc1
  s_waitcnt vmcnt(4)
  s_add_u32 s53, s44, 4
  v_subrev_u32 v109, s53, v109
  v_cmp_lt_u32 vcc, 7, v109
  s_cbranch_vccnz Lretry13
Lresume14:
  buffer_load_dwordx4 v[112:115], v212, s[36:39], s63 offen offset:0 sc1
  buffer_load_dwordx4 v[116:119], v212, s[36:39], s63 offen offset:1024 sc1
  buffer_load_dwordx4 v[120:123], v212, s[36:39], s63 offen offset:2048 sc1
  buffer_load_dwordx4 v[124:127], v212, s[36:39], s63 offen offset:3072 sc1
  buffer_load_dwordx4 v[128:131], v212, s[36:39], s68 offen offset:0 sc1
  buffer_load_dwordx4 v[132:135], v213, s[36:39], s63 offen offset:0 sc1
  buffer_load_dwordx4 v[136:139], v213, s[36:39], s63 offen offset:1024 sc1
  v_mov_b32 v32, 0x3f803f80
  v_mov_b32 v33, 0x3f803f80
  v_mov_b32 v34, 0x3f803f80
  v_mov_b32 v35, 0x3f803f80
  s_waitcnt lgkmcnt(15)
  s_nop 0
  v_mfma_f32_16x16x32_bf16 v[20:23], a[0:3], v[32:35], v[20:23]
  v_mfma_f32_16x16x32_bf16 v[24:27], a[4:7], v[32:35], v[24:27]
  v_mfma_f32_16x16x32_bf16 v[28:31], a[8:11], v[32:35], v[28:31]
  s_waitcnt lgkmcnt(15)
  v_mfma_f32_16x16x32_bf16 v[20:23], a[12:15], v[32:35], v[20:23]
  v_mfma_f32_16x16x32_bf16 v[24:27], a[16:19], v[32:35], v[24:27]
  v_mfma_f32_16x16x32_bf16 v[28:31], a[20:23], v[32:35], v[28:31]
  s_waitcnt lgkmcnt(15)
  v_mfma_f32_16x16x32_bf16 v[20:23], a[24:27], v[32:35], v[20:23]
  v_mfma_f32_16x16x32_bf16 v[24:27], a[28:31], v[32:35], v[24:27]
  v_mfma_f32_16x16x32_bf16 v[28:31], a[32:35], v[32:35], v[28:31]
  s_waitcnt lgkmcnt(15)
  v_mfma_f32_16x16x32_bf16 v[20:23], a[36:39], v[32:35], v[20:23]
  v_mfma_f32_16x16x32_bf16 v[24:27], a[40:43], v[32:35], v[24:27]
  v_mfma_f32_16x16x32_bf16 v[28:31], a[44:47], v[32:35], v[28:31]
  s_waitcnt lgkmcnt(15)
  v_mfma_f32_16x16x32_bf16 v[20:23], a[48:51], v[32:35], v[20:23]
  v_mfma_f32_16x16x32_bf16 v[24:27], a[52:55], v[32:35], v[24:27]
  v_mfma_f32_16x16x32_bf16 v[28:31], a[56:59], v[32:35], v[28:31]
  s_waitcnt lgkmcnt(12)
  v_mfma_f32_16x16x32_bf16 v[20:23], a[60:63], v[32:35], v[20:23]
  v_mfma_f32_16x16x32_bf16 v[24:27], a[64:67], v[32:35], v[24:27]
  v_mfma_f32_16x16x32_bf16 v[28:31], a[68:71], v[32:35], v[28:31]
  s_waitcnt lgkmcnt(6)
  v_mfma_f32_16x16x32_bf16 v[20:23], a[72:75], v[32:35], v[20:23]
  v_mfma_f32_16x16x32_bf16 v[24:27], a[76:79], v[32:35], v[24:27]
  v_mfma_f32_16x16x32_bf16 v[28:31], a[80:83], v[32:35], v[28:31]
  s_waitcnt lgkmcnt(0)
  v_mfma_f32_16x16x32_bf16 v[20:23], a[84:87], v[32:35], v[20:23]
  v_mfma_f32_16x16x32_bf16 v[24:27], a[88:91], v[32:35], v[24:27]
  v_mfma_f32_16x16x32_bf16 v[28:31], a[92:95], v[32:35], v[28:31]
  s_waitcnt vmcnt(6)
  v_mfma_f32_16x16x32_bf16 v[52:55], a[100:103], v[112:115], 0
  v_mfma_f32_16x16x32_bf16 v[56:59], a[104:107], v[112:115], 0
  v_mfma_f32_16x16x32_bf16 v[60:63], a[108:111], v[112:115], 0
  buffer_load_dwordx4 v[140:143], v213, s[36:39], s63 offen offset:2048 sc1
  v_mfma_f32_16x16x32_bf16 v[64:67], a[112:115], v[112:115], 0
  v_mfma_f32_16x16x32_bf16 v[68:71], a[116:119], v[112:115], 0
  s_waitcnt vmcnt(6)
  v_mfma_f32_16x16x32_bf16 v[52:55], a[120:123], v[116:119], v[52:55]
  v_mfma_f32_16x16x32_bf16 v[56:59], a[124:127], v[116:119], v[56:59]
  v_mfma_f32_16x16x32_bf16 v[60:63], a[128:131], v[116:119], v[60:63]
  buffer_load_dwordx4 v[144:147], v213, s[36:39], s63 offen offset:3072 sc1
  v_mfma_f32_16x16x32_bf16 v[64:67], a[132:135], v[116:119], v[64:67]
  v_mfma_f32_16x16x32_bf16 v[68:71], a[136:139], v[116:119], v[68:71]
  s_waitcnt vmcnt(6)
  v_mfma_f32_16x16x32_bf16 v[52:55], a[140:143], v[120:123], v[52:55]
  v_mfma_f32_16x16x32_bf16 v[56:59], a[144:147], v[120:123], v[56:59]
  v_mfma_f32_16x16x32_bf16 v[60:63], a[148:151], v[120:123], v[60:63]
  buffer_load_dwordx4 v[148:151], v213, s[36:39], s68 offen offset:0 sc1
  v_mfma_f32_16x16x32_bf16 v[64:67], a[152:155], v[120:123], v[64:67]
  v_mfma_f32_16x16x32_bf16 v[68:71], a[156:159], v[120:123], v[68:71]
  s_waitcnt vmcnt(6)
  v_mfma_f32_16x16x32_bf16 v[52:55], a[160:163], v[124:127], v[52:55]
  v_mfma_f32_16x16x32_bf16 v[56:59], a[164:167], v[124:127], v[56:59]
  v_mfma_f32_16x16x32_bf16 v[60:63], a[168:171], v[124:127], v[60:63]
  buffer_load_dwordx4 v[152:155], v214, s[36:39], s63 offen offset:0 sc1
  v_mfma_f32_16x16x32_bf16 v[64:67], a[172:175], v[124:127], v[64:67]
  v_mfma_f32_16x16x32_bf16 v[68:71], a[176:179], v[124:127], v[68:71]
  s_waitcnt vmcnt(6)
  v_mfma_f32_16x16x32_bf16 v[52:55], a[180:183], v[128:131], v[52:55]
  v_mfma_f32_16x16x32_bf16 v[56:59], a[184:187], v[128:131], v[56:59]
  v_mfma_f32_16x16x32_bf16 v[60:63], a[188:191], v[128:131], v[60:63]
  buffer_load_dwordx4 v[156:159], v214, s[36:39], s63 offen offset:1024 sc1
  v_mfma_f32_16x16x32_bf16 v[64:67], a[192:195], v[128:131], v[64:67]
  v_mfma_f32_16x16x32_bf16 v[68:71], a[196:199], v[128:131], v[68:71]
  s_waitcnt vmcnt(6)
  v_mfma_f32_16x16x32_bf16 v[72:75], a[100:103], v[132:135], 0
  v_mfma_f32_16x16x32_bf16 v[76:79], a[104:107], v[132:135], 0
  v_mfma_f32_16x16x32_bf16 v[80:83], a[108:111], v[132:135], 0
  buffer_load_dwordx4 v[160:163], v214, s[36:39], s63 offen offset:2048 sc1
  v_mfma_f32_16x16x32_bf16 v[84:87], a[112:115], v[132:135], 0
  v_mfma_f32_16x16x32_bf16 v[88:91], a[116:119], v[132:135], 0
  s_waitcnt vmcnt(6)
  v_mfma_f32_16x16x32_bf16 v[72:75], a[120:123], v[136:139], v[72:75]
  v_add_u32 v16, s74, v2
  ds_write_b128 v16, v[52:55] offset:0
  v_mfma_f32_16x16x32_bf16 v[76:79], a[124:127], v[136:139], v[76:79]
  ds_write_b128 v16, v[56:59] offset:1024
  v_mfma_f32_16x16x32_bf16 v[80:83], a[128:131], v[136:139], v[80:83]
  ds_write_b128 v16, v[60:63] offset:2048
  v_mfma_f32_16x16x32_bf16 v[84:87], a[132:135], v[136:139], v[84:87]
  buffer_load_dwordx4 v[164:167], v214, s[36:39], s63 offen offset:3072 sc1
  v_mfma_f32_16x16x32_bf16 v[88:91], a[136:139], v[136:139], v[88:91]
  s_waitcnt vmcnt(6)
  v_mfma_f32_16x16x32_bf16 v[72:75], a[140:143], v[140:143], v[72:75]
  v_mfma_f32_16x16x32_bf16 v[76:79], a[144:147], v[140:143], v[76:79]
  ds_write_b128 v16, v[64:67] offset:3072
  ds_write_b128 v16, v[68:71] offset:4096
  v_mfma_f32_16x16x32_bf16 v[80:83], a[148:151], v[140:143], v[80:83]
  v_mfma_f32_16x16x32_bf16 v[84:87], a[152:155], v[140:143], v[84:87]
  buffer_load_dwordx4 v[168:171], v214, s[36:39], s68 offen offset:0 sc1
  v_mfma_f32_16x16x32_bf16 v[88:91], a[156:159], v[140:143], v[88:91]
  s_waitcnt vmcnt(6)
  v_mfma_f32_16x16x32_bf16 v[72:75], a[160:163], v[144:147], v[72:75]
  buffer_load_dwordx4 v[172:175], v215, s[36:39], s63 offen offset:0 sc1
  v_mfma_f32_16x16x32_bf16 v[76:79], a[164:167], v[144:147], v[76:79]
  s_mov_b32 s65, s46
  s_and_b32 s53, s65, 1
  s_mul_i32 s54, s65, 80
  v_mfma_f32_16x16x32_bf16 v[80:83], a[168:171], v[144:147], v[80:83]
  s_lshl_b32 s66, s53, 4
  s_add_u32 s66, s66, s54
  s_xor_b32 s53, s53, 1
  s_mul_i32 s67, s53, 64
  v_mfma_f32_16x16x32_bf16 v[84:87], a[172:175], v[144:147], v[84:87]
  s_add_u32 s67, s67, s54
  s_lshl_b32 s64, s45, 2
  s_add_u32 s64, s64, s3
  s_mul_i32 s60, s64, 20480
  v_mfma_f32_16x16x32_bf16 v[88:91], a[176:179], v[144:147], v[88:91]
  v_and_b32 v18, 1, v5
  v_lshlrev_b32 v18, 1, v18
  v_lshrrev_b32 v17, 1, v5
  s_waitcnt vmcnt(6)
  v_mfma_f32_16x16x32_bf16 v[72:75], a[180:183], v[148:151], v[72:75]
  v_or_b32 v18, v18, v17
  v_lshlrev_b32 v18, 8, v18
  v_lshl_add_u32 v18, v4, 4, v18
  v_lshrrev_b32 v19, 1, v5
  v_mfma_f32_16x16x32_bf16 v[76:79], a[184:187], v[148:151], v[76:79]
  v_lshlrev_b32 v19, 8, v19
  v_lshl_add_u32 v19, v4, 4, v19
  v_and_b32 v17, 1, v5
  v_lshl_add_u32 v19, v17, 3, v19
  v_mfma_f32_16x16x32_bf16 v[80:83], a[188:191], v[148:151], v[80:83]
  s_lshl_b32 s61, s66, 5
  s_add_u32 s61, s61, s60
  s_add_u32 s61, s61, 13926400
  s_lshl_b32 s62, s67, 5
  v_mfma_f32_16x16x32_bf16 v[84:87], a[192:195], v[148:151], v[84:87]
  s_add_u32 s62, s62, s60
  s_add_u32 s62, s62, 13926400
  v_add_u32 v17, s77, v2
  v_mfma_f32_16x16x32_bf16 v[88:91], a[196:199], v[148:151], v[88:91]
  buffer_load_dwordx4 v[176:179], v215, s[36:39], s63 offen offset:1024 sc1
  s_waitcnt vmcnt(6)
  v_mfma_f32_16x16x32_bf16 v[92:95], a[100:103], v[152:155], 0
  v_mfma_f32_16x16x32_bf16 v[96:99], a[104:107], v[152:155], 0
  v_mfma_f32_16x16x32_bf16 v[100:103], a[108:111], v[152:155], 0
  buffer_load_dwordx4 v[180:183], v215, s[36:39], s63 offen offset:2048 sc1
  v_mfma_f32_16x16x32_bf16 v[104:107], a[112:115], v[152:155], 0
  v_mfma_f32_16x16x32_bf16 v[108:111], a[116:119], v[152:155], 0
  s_waitcnt vmcnt(6)
  v_mfma_f32_16x16x32_bf16 v[92:95], a[120:123], v[156:159], v[92:95]
  v_add_u32 v16, s75, v2
  ds_write_b128 v16, v[72:75] offset:0
  ds_write_b128 v16, v[76:79] offset:1024
  v_mfma_f32_16x16x32_bf16 v[96:99], a[124:127], v[156:159], v[96:99]
  ds_write_b128 v16, v[80:83] offset:2048
  v_mfma_f32_16x16x32_bf16 v[100:103], a[128:131], v[156:159], v[100:103]
  buffer_load_dwordx4 v[184:187], v215, s[36:39], s63 offen offset:3072 sc1
  v_mfma_f32_16x16x32_bf16 v[104:107], a[132:135], v[156:159], v[104:107]
  s_waitcnt vmcnt(19)
  v_cmp_gt_u32 vcc, 96, v0
  s_cbranch_vccnz Lretry11
Lresume12:
  v_mfma_f32_16x16x32_bf16 v[108:111], a[136:139], v[156:159], v[108:111]
  ds_write_b128 v16, v[84:87] offset:3072
  ds_write_b128 v16, v[88:91] offset:4096
  s_waitcnt vmcnt(6)
  v_mfma_f32_16x16x32_bf16 v[92:95], a[140:143], v[160:163], v[92:95]
  buffer_load_dwordx4 v[188:191], v215, s[36:39], s68 offen offset:0 sc1
  v_mfma_f32_16x16x32_bf16 v[96:99], a[144:147], v[160:163], v[96:99]
  s_add_u32 s51, s50, 22970368
  v_mfma_f32_16x16x32_bf16 v[100:103], a[148:151], v[160:163], v[100:103]
  s_add_u32 m0, s47, 18432
  v_mfma_f32_16x16x32_bf16 v[104:107], a[152:155], v[160:163], v[104:107]
  buffer_load_dwordx4 v6, s[8:11], s51 offen offset:0 sc1 lds
  v_mfma_f32_16x16x32_bf16 v[108:111], a[156:159], v[160:163], v[108:111]
  s_waitcnt vmcnt(7)
  v_mfma_f32_16x16x32_bf16 v[92:95], a[160:163], v[164:167], v[92:95]
  buffer_load_dwordx4 v6, s[8:11], s51 offen offset:1024 sc1 lds
  v_mfma_f32_16x16x32_bf16 v[96:99], a[164:167], v[164:167], v[96:99]
  v_mfma_f32_16x16x32_bf16 v[100:103], a[168:171], v[164:167], v[100:103]
  v_permlane16_swap_b32 v192, v194
  v_permlane16_swap_b32 v193, v195
  v_permlane16_swap_b32 v196, v198
  v_permlane16_swap_b32 v197, v199
  v_mfma_f32_16x16x32_bf16 v[104:107], a[172:175], v[164:167], v[104:107]
  v_lshlrev_b32 v112, 16, v192
  v_and_b32 v113, 0xffff0000, v192
  v_lshlrev_b32 v114, 16, v193
  v_and_b32 v115, 0xffff0000, v193
  v_mfma_f32_16x16x32_bf16 v[108:111], a[176:179], v[164:167], v[108:111]
  v_lshlrev_b32 v116, 16, v194
  v_and_b32 v117, 0xffff0000, v194
  v_lshlrev_b32 v118, 16, v195
  v_and_b32 v119, 0xffff0000, v195
  s_waitcnt vmcnt(7)
  v_mfma_f32_16x16x32_bf16 v[92:95], a[180:183], v[168:171], v[92:95]
  v_lshlrev_b32 v120, 16, v196
  v_and_b32 v121, 0xffff0000, v196
  v_lshlrev_b32 v122, 16, v197
  v_and_b32 v123, 0xffff0000, v197
  v_mfma_f32_16x16x32_bf16 v[96:99], a[184:187], v[168:171], v[96:99]
  v_lshlrev_b32 v124, 16, v198
  v_and_b32 v125, 0xffff0000, v198
  v_lshlrev_b32 v126, 16, v199
  v_and_b32 v127, 0xffff0000, v199
  v_mfma_f32_16x16x32_bf16 v[100:103], a[188:191], v[168:171], v[100:103]
  v_lshlrev_b32 v128, 16, v200
  v_and_b32 v129, 0xffff0000, v200
  v_lshlrev_b32 v130, 16, v201
  v_and_b32 v131, 0xffff0000, v201
  v_mfma_f32_16x16x32_bf16 v[104:107], a[192:195], v[168:171], v[104:107]
  v_mfma_f32_16x16x32_bf16 v[108:111], a[196:199], v[168:171], v[108:111]
  buffer_load_dwordx4 v6, s[8:11], s51 offen offset:2048 sc1 lds
  s_waitcnt vmcnt(7)
  v_mfma_f32_16x16x32_bf16 v[32:35], a[100:103], v[172:175], 0
  v_mfma_f32_16x16x32_bf16 v[36:39], a[104:107], v[172:175], 0
  v_mfma_f32_16x16x32_bf16 v[40:43], a[108:111], v[172:175], 0
  buffer_load_dwordx4 v6, s[8:11], s51 offen offset:3072 sc1 lds
  v_mfma_f32_16x16x32_bf16 v[44:47], a[112:115], v[172:175], 0
  v_mfma_f32_16x16x32_bf16 v[48:51], a[116:119], v[172:175], 0
  s_waitcnt vmcnt(7)
  v_mfma_f32_16x16x32_bf16 v[32:35], a[120:123], v[176:179], v[32:35]
  v_add_u32 v16, s76, v2
  ds_write_b128 v16, v[92:95] offset:0
  ds_write_b128 v16, v[96:99] offset:1024
  v_mfma_f32_16x16x32_bf16 v[36:39], a[124:127], v[176:179], v[36:39]
  ds_write_b128 v16, v[100:103] offset:2048
  s_add_u32 m0, s47, 22528
  v_mfma_f32_16x16x32_bf16 v[40:43], a[128:131], v[176:179], v[40:43]
  v_mfma_f32_16x16x32_bf16 v[44:47], a[132:135], v[176:179], v[44:47]
  buffer_load_dwordx4 v7, s[8:11], s51 offen offset:0 sc1 lds
  v_mfma_f32_16x16x32_bf16 v[48:51], a[136:139], v[176:179], v[48:51]
  s_waitcnt vmcnt(7)
  v_mfma_f32_16x16x32_bf16 v[32:35], a[140:143], v[180:183], v[32:35]
  ds_write_b128 v16, v[104:107] offset:3072
  ds_write_b128 v16, v[108:111] offset:4096
  v_mfma_f32_16x16x32_bf16 v[36:39], a[144:147], v[180:183], v[36:39]
  s_add_u32 s51, s50, 23011328
  s_add_u32 m0, s47, 23552
  v_mfma_f32_16x16x32_bf16 v[40:43], a[148:151], v[180:183], v[40:43]
  v_mfma_f32_16x16x32_bf16 v[44:47], a[152:155], v[180:183], v[44:47]
  buffer_load_dwordx4 v6, s[8:11], s51 offen offset:0 sc1 lds
  v_mfma_f32_16x16x32_bf16 v[48:51], a[156:159], v[180:183], v[48:51]
  s_waitcnt vmcnt(7)
  v_mfma_f32_16x16x32_bf16 v[32:35], a[160:163], v[184:187], v[32:35]
  v_mfma_f32_16x16x32_bf16 v[36:39], a[164:167], v[184:187], v[36:39]
  v_mfma_f32_16x16x32_bf16 v[40:43], a[168:171], v[184:187], v[40:43]
  buffer_load_dwordx4 v6, s[8:11], s51 offen offset:1024 sc1 lds
  v_mfma_f32_16x16x32_bf16 v[44:47], a[172:175], v[184:187], v[44:47]
  v_mfma_f32_16x16x32_bf16 v[48:51], a[176:179], v[184:187], v[48:51]
  s_waitcnt lgkmcnt(0)
  s_barrier
  ds_read_b128 v[92:95], v17 offset:0
  ds_read_b128 v[96:99], v17 offset:1024
  ds_read_b128 v[100:103], v17 offset:2048
  ds_read_b128 v[104:107], v17 offset:3072
  ds_read_b128 v[108:111], v17 offset:4096
  ds_read_b128 v[52:55], v17 offset:5120
  ds_read_b128 v[56:59], v17 offset:6144
  ds_read_b128 v[60:63], v17 offset:7168
  ds_read_b128 v[64:67], v17 offset:8192
  ds_read_b128 v[68:71], v17 offset:9216
  ds_read_b128 v[72:75], v17 offset:10240
  ds_read_b128 v[76:79], v17 offset:11264
  ds_read_b128 v[80:83], v17 offset:12288
  ds_read_b128 v[84:87], v17 offset:13312
  ds_read_b128 v[88:91], v17 offset:14336
  s_waitcnt vmcnt(7)
  v_mfma_f32_16x16x32_bf16 v[32:35], a[180:183], v[188:191], v[32:35]
  s_add_u32 s51, s50, 23052288
  v_mfma_f32_16x16x32_bf16 v[36:39], a[184:187], v[188:191], v[36:39]
  v_mfma_f32_16x16x32_bf16 v[40:43], a[188:191], v[188:191], v[40:43]
  buffer_load_dwordx4 a[96:99], v6, s[8:11], s51 offen offset:3072 sc1
  v_mfma_f32_16x16x32_bf16 v[44:47], a[192:195], v[188:191], v[44:47]
  v_mfma_f32_16x16x32_bf16 v[48:51], a[196:199], v[188:191], v[48:51]
  s_waitcnt lgkmcnt(5)
  v_pk_add_f32 v[92:93], v[92:93], v[52:53]
  v_pk_add_f32 v[94:95], v[94:95], v[54:55]
  v_pk_add_f32 v[96:97], v[96:97], v[56:57]
  v_pk_add_f32 v[98:99], v[98:99], v[58:59]
  v_pk_add_f32 v[32:33], v[32:33], v[112:113]
  v_pk_add_f32 v[34:35], v[34:35], v[114:115]
  v_pk_add_f32 v[36:37], v[36:37], v[116:117]
  v_pk_add_f32 v[38:39], v[38:39], v[118:119]
  s_waitcnt lgkmcnt(0)
  v_pk_add_f32 v[32:33], v[32:33], v[72:73]
  v_pk_add_f32 v[34:35], v[34:35], v[74:75]
  v_pk_add_f32 v[36:37], v[36:37], v[76:77]
  v_pk_add_f32 v[38:39], v[38:39], v[78:79]
  v_pk_add_f32 v[32:33], v[32:33], v[92:93]
  v_pk_add_f32 v[34:35], v[34:35], v[94:95]
  v_pk_add_f32 v[36:37], v[36:37], v[96:97]
  v_pk_add_f32 v[38:39], v[38:39], v[98:99]
  v_cvt_pk_bf16_f32 v132, v32, v33
  v_cvt_pk_bf16_f32 v133, v34, v35
  v_cvt_pk_bf16_f32 v134, v36, v37
  v_cvt_pk_bf16_f32 v135, v38, v39
  s_nop 0
  v_permlane16_swap_b32 v132, v134
  v_permlane16_swap_b32 v133, v135
  buffer_store_dwordx4 v[132:135], v18, s[8:11], s61 offen offset:0 sc1
  v_pk_add_f32 v[100:101], v[100:101], v[60:61]
  v_pk_add_f32 v[102:103], v[102:103], v[62:63]
  v_pk_add_f32 v[104:105], v[104:105], v[64:65]
  v_pk_add_f32 v[106:107], v[106:107], v[66:67]
  v_pk_add_f32 v[40:41], v[40:41], v[120:121]
  v_pk_add_f32 v[42:43], v[42:43], v[122:123]
  v_pk_add_f32 v[44:45], v[44:45], v[124:125]
  v_pk_add_f32 v[46:47], v[46:47], v[126:127]
  v_pk_add_f32 v[40:41], v[40:41], v[80:81]
  v_pk_add_f32 v[42:43], v[42:43], v[82:83]
  v_pk_add_f32 v[44:45], v[44:45], v[84:85]
  v_pk_add_f32 v[46:47], v[46:47], v[86:87]
  v_pk_add_f32 v[40:41], v[40:41], v[100:101]
  v_pk_add_f32 v[42:43], v[42:43], v[102:103]
  v_pk_add_f32 v[44:45], v[44:45], v[104:105]
  v_pk_add_f32 v[46:47], v[46:47], v[106:107]
  v_cvt_pk_bf16_f32 v136, v40, v41
  v_cvt_pk_bf16_f32 v137, v42, v43
  v_cvt_pk_bf16_f32 v138, v44, v45
  v_cvt_pk_bf16_f32 v139, v46, v47
  s_nop 0
  v_permlane16_swap_b32 v136, v138
  v_permlane16_swap_b32 v137, v139
  buffer_store_dwordx4 v[136:139], v18, s[8:11], s61 offen offset:1024 sc1
  v_pk_add_f32 v[108:109], v[108:109], v[68:69]
  v_pk_add_f32 v[110:111], v[110:111], v[70:71]
  v_pk_add_f32 v[48:49], v[48:49], v[128:129]
  v_pk_add_f32 v[50:51], v[50:51], v[130:131]
  v_pk_add_f32 v[48:49], v[48:49], v[88:89]
  v_pk_add_f32 v[50:51], v[50:51], v[90:91]
  v_pk_add_f32 v[48:49], v[48:49], v[108:109]
  v_pk_add_f32 v[50:51], v[50:51], v[110:111]
  v_cvt_pk_bf16_f32 v140, v48, v49
  v_cvt_pk_bf16_f32 v141, v50, v51
  buffer_store_dwordx2 v[140:141], v19, s[8:11], s62 offen sc1
  v_pk_add_f32 v[92:93], v[32:33], v[34:35]
  v_pk_add_f32 v[94:95], v[36:37], v[38:39]
  v_pk_add_f32 v[92:93], v[92:93], v[40:41]
  v_pk_add_f32 v[94:95], v[94:95], v[42:43]
  v_pk_add_f32 v[92:93], v[92:93], v[44:45]
  v_pk_add_f32 v[94:95], v[94:95], v[46:47]
  v_pk_add_f32 v[92:93], v[92:93], v[48:49]
  v_pk_add_f32 v[94:95], v[94:95], v[50:51]
  v_pk_add_f32 v[92:93], v[92:93], v[94:95]
  v_add_f32 v92, v92, v93
  v_mov_b32 v93, v92
  s_nop 1
  v_permlane16_swap_b32 v92, v93
  v_add_f32 v92, v92, v93
  v_mov_b32 v93, v92
  s_nop 1
  v_permlane32_swap_b32 v92, v93
  v_add_f32 v92, v92, v93
  v_mul_f32 v92, 0x3c4ccccd, v92
  v_pk_add_f32 v[72:73], v[32:33], v[92:93] op_sel_hi:[1,0] neg_lo:[0,1] neg_hi:[0,1]
  v_pk_add_f32 v[74:75], v[34:35], v[92:93] op_sel_hi:[1,0] neg_lo:[0,1] neg_hi:[0,1]
  v_pk_add_f32 v[76:77], v[36:37], v[92:93] op_sel_hi:[1,0] neg_lo:[0,1] neg_hi:[0,1]
  v_pk_add_f32 v[78:79], v[38:39], v[92:93] op_sel_hi:[1,0] neg_lo:[0,1] neg_hi:[0,1]
  v_pk_add_f32 v[80:81], v[40:41], v[92:93] op_sel_hi:[1,0] neg_lo:[0,1] neg_hi:[0,1]
  v_pk_add_f32 v[82:83], v[42:43], v[92:93] op_sel_hi:[1,0] neg_lo:[0,1] neg_hi:[0,1]
  v_pk_add_f32 v[84:85], v[44:45], v[92:93] op_sel_hi:[1,0] neg_lo:[0,1] neg_hi:[0,1]
  v_pk_add_f32 v[86:87], v[46:47], v[92:93] op_sel_hi:[1,0] neg_lo:[0,1] neg_hi:[0,1]
  v_pk_add_f32 v[88:89], v[48:49], v[92:93] op_sel_hi:[1,0] neg_lo:[0,1] neg_hi:[0,1]
  v_pk_add_f32 v[90:91], v[50:51], v[92:93] op_sel_hi:[1,0] neg_lo:[0,1] neg_hi:[0,1]
  v_pk_mul_f32 v[94:95], v[72:73], v[72:73]
  v_pk_mul_f32 v[96:97], v[74:75], v[74:75]
  v_pk_fma_f32 v[94:95], v[76:77], v[76:77], v[94:95]
  v_pk_fma_f32 v[96:97], v[78:79], v[78:79], v[96:97]
  v_pk_fma_f32 v[94:95], v[80:81], v[80:81], v[94:95]
  v_pk_fma_f32 v[96:97], v[82:83], v[82:83], v[96:97]
  v_pk_fma_f32 v[94:95], v[84:85], v[84:85], v[94:95]
  v_pk_fma_f32 v[96:97], v[86:87], v[86:87], v[96:97]
  v_pk_fma_f32 v[94:95], v[88:89], v[88:89], v[94:95]
  v_pk_fma_f32 v[96:97], v[90:91], v[90:91], v[96:97]
  v_pk_add_f32 v[94:95], v[94:95], v[96:97]
  v_add_f32 v93, v94, v95
  v_mov_b32 v94, v93
  s_nop 1
  v_permlane16_swap_b32 v93, v94
  v_add_f32 v93, v93, v94
  v_mov_b32 v94, v93
  s_nop 1
  v_permlane32_swap_b32 v93, v94
  v_add_f32 v93, v93, v94
  s_lshl_b32 s53, s64, 10
  s_lshl_b32 s54, s46, 7
  s_add_u32 s53, s53, s54
  s_add_u32 s53, s53, 16547840
  v_lshlrev_b32 v16, 3, v4
  s_mov_b64 exec, 0xffff
  buffer_store_dwordx2 v[92:93], v16, s[8:11], s53 offen sc1
  s_mov_b64 exec, -1
  v_mov_b32 v96, v204
  v_mov_b32 v98, v205
  v_pk_fma_f32 v[112:113], v[112:113], v[98:99], v[32:33] op_sel_hi:[1,0,1]
  v_pk_fma_f32 v[114:115], v[114:115], v[98:99], v[34:35] op_sel_hi:[1,0,1]
  v_pk_fma_f32 v[116:117], v[116:117], v[98:99], v[36:37] op_sel_hi:[1,0,1]
  v_pk_fma_f32 v[118:119], v[118:119], v[98:99], v[38:39] op_sel_hi:[1,0,1]
  v_pk_fma_f32 v[120:121], v[120:121], v[98:99], v[40:41] op_sel_hi:[1,0,1]
  v_pk_fma_f32 v[122:123], v[122:123], v[98:99], v[42:43] op_sel_hi:[1,0,1]
  v_pk_fma_f32 v[124:125], v[124:125], v[98:99], v[44:45] op_sel_hi:[1,0,1]
  v_pk_fma_f32 v[126:127], v[126:127], v[98:99], v[46:47] op_sel_hi:[1,0,1]
  v_pk_fma_f32 v[128:129], v[128:129], v[98:99], v[48:49] op_sel_hi:[1,0,1]
  v_pk_fma_f32 v[130:131], v[130:131], v[98:99], v[50:51] op_sel_hi:[1,0,1]
  v_pk_add_f32 v[192:193], v[112:113], v[96:97] op_sel_hi:[1,0]
  v_pk_add_f32 v[194:195], v[114:115], v[96:97] op_sel_hi:[1,0]
  v_pk_add_f32 v[196:197], v[116:117], v[96:97] op_sel_hi:[1,0]
  v_pk_add_f32 v[198:199], v[118:119], v[96:97] op_sel_hi:[1,0]
  v_pk_add_f32 v[200:201], v[120:121], v[96:97] op_sel_hi:[1,0]
  v_pk_add_f32 v[202:203], v[122:123], v[96:97] op_sel_hi:[1,0]
  v_pk_add_f32 v[204:205], v[124:125], v[96:97] op_sel_hi:[1,0]
  v_pk_add_f32 v[206:207], v[126:127], v[96:97] op_sel_hi:[1,0]
  v_pk_add_f32 v[208:209], v[128:129], v[96:97] op_sel_hi:[1,0]
  v_pk_add_f32 v[210:211], v[130:131], v[96:97] op_sel_hi:[1,0]
  s_lshl_b32 s64, s45, 2
  s_waitcnt vmcnt(43)
  s_mul_i32 s60, s64, 20480
  ds_read_b64_tr_b16 a[100:101], v15 offset:6144
  s_mul_i32 s55, s3, 5120
  ds_read_b64_tr_b16 a[102:103], v15 offset:6912
  s_add_u32 s60, s60, s55
  ds_read_b64_tr_b16 a[104:105], v15 offset:6176
  s_add_u32 s60, s60, 13926400
  ds_read_b64_tr_b16 a[106:107], v15 offset:6944
  s_add_u32 s61, s60, 20480
  ds_read_b64_tr_b16 a[108:109], v15 offset:6208
  s_add_u32 s62, s60, 40960
  ds_read_b64_tr_b16 a[110:111], v15 offset:6976
  s_add_u32 s63, s60, 61440
  s_waitcnt vmcnt(40)
  v_add_u32 v17, 2048, v2
  ds_read_b64_tr_b16 a[112:113], v15 offset:9216
  s_cmp_eq_u32 s3, 3
  s_cselect_b32 s55, 61440, s55
  ds_read_b64_tr_b16 a[114:115], v15 offset:9984
  ds_read_b64_tr_b16 a[116:117], v15 offset:9248
  s_movk_i32 s56, 15360
  s_cselect_b32 s56, 25600, s56
  ds_read_b64_tr_b16 a[118:119], v15 offset:10016
  ds_read_b64_tr_b16 a[120:121], v15 offset:9280
  v_add_u32 v212, s55, v2
  ds_read_b64_tr_b16 a[122:123], v15 offset:10048
  s_mov_b32 s71, s55
  s_waitcnt vmcnt(37)
  s_add_u32 s55, s55, s56
  ds_read_b64_tr_b16 a[124:125], v15 offset:12288
  v_add_u32 v213, s55, v2
  ds_read_b64_tr_b16 a[126:127], v15 offset:13056
  s_mov_b32 s75, s55
  ds_read_b64_tr_b16 a[128:129], v15 offset:12320
  s_add_u32 s55, s55, s56
  ds_read_b64_tr_b16 a[130:131], v15 offset:13088
  v_add_u32 v214, s55, v2
  ds_read_b64_tr_b16 a[132:133], v15 offset:12352
  s_mov_b32 s76, s55
  ds_read_b64_tr_b16 a[134:135], v15 offset:13120
  s_add_u32 s55, s55, s56
  s_waitcnt vmcnt(33)
  v_add_u32 v215, s55, v2
  ds_read_b64_tr_b16 a[136:137], v15 offset:15360
  s_mov_b32 s77, s55
  ds_read_b64_tr_b16 a[138:139], v15 offset:16128
  s_add_u32 s55, s55, s56
  ds_read_b64_tr_b16 a[140:141], v15 offset:15392
  s_add_u32 s74, s64, s3
  ds_read_b64_tr_b16 a[142:143], v15 offset:16160
  s_lshl_b32 s74, s74, 10
  ds_read_b64_tr_b16 a[144:145], v15 offset:15424
  s_add_u32 s74, s74, 16547840
  ds_read_b64_tr_b16 a[146:147], v15 offset:16192
  s_barrier
  v_lshlrev_b32 v16, 3, v4
  v_lshl_add_u32 v16, v5, 8, v16
  s_mov_b32 m0, s71
  s_nop 0
  buffer_load_dwordx4 v2, s[8:11], s60 offen offset:0 sc1 lds
  buffer_load_dwordx4 v2, s[8:11], s60 offen offset:1024 sc1 lds
  buffer_load_dwordx4 v2, s[8:11], s60 offen offset:2048 sc1 lds
  buffer_load_dwordx4 v2, s[8:11], s60 offen offset:3072 sc1 lds
  s_addk_i32 m0, 2048
  s_nop 0
  buffer_load_dwordx4 v17, s[8:11], s60 offen offset:2048 sc1 lds
  buffer_load_dwordx2 v[76:77], v16, s[8:11], s74 offen sc1
  buffer_load_dwordx2 v[78:79], v16, s[8:11], s74 offen offset:128 sc1
  s_mov_b32 m0, s75
  s_nop 0
  buffer_load_dwordx4 v2, s[8:11], s61 offen offset:0 sc1 lds
  buffer_load_dwordx4 v2, s[8:11], s61 offen offset:1024 sc1 lds
  buffer_load_dwordx4 v2, s[8:11], s61 offen offset:2048 sc1 lds
  buffer_load_dwordx4 v2, s[8:11], s61 offen offset:3072 sc1 lds
  s_addk_i32 m0, 2048
  s_nop 0
  buffer_load_dwordx4 v17, s[8:11], s61 offen offset:2048 sc1 lds
  s_lshl_b32 s65, s46, 2
  s_add_u32 s65, s65, s3
  s_and_b32 s53, s65, 1
  s_mul_i32 s54, s65, 48
  s_lshl_b32 s66, s53, 4
  s_add_u32 s66, s66, s54
  s_xor_b32 s53, s53, 1
  s_mul_i32 s67, s53, 32
  s_add_u32 s67, s67, s54
  v_add_u32 v74, 61440, v2
  v_add_u32 v75, 87040, v2
  s_mul_i32 s70, s64, 49152
  s_lshl_b32 s66, s66, 5
  s_add_u32 s66, s66, 16678912
  s_add_u32 s66, s66, s70
  s_lshl_b32 s67, s67, 5
  s_add_u32 s67, s67, 16678912
  s_add_u32 s67, s67, s70
  s_waitcnt vmcnt(17)
  ds_read_b128 a[148:151], v8 offset:18432
  ds_read_b128 a[152:155], v8 offset:19456
  ds_read_b128 a[156:159], v8 offset:20480
  ds_read_b128 a[160:163], v8 offset:21504
  ds_read_b128 a[164:167], v8 offset:22528
  ds_read_b128 a[168:171], v8 offset:23552
  ds_read_b128 a[172:175], v8 offset:24576
  v_mov_b32 v32, 0x3f803f80
  v_mov_b32 v33, 0x3f803f80
  v_mov_b32 v34, 0x3f803f80
  v_mov_b32 v35, 0x3f803f80
  s_waitcnt lgkmcnt(15)
  s_nop 0
  v_mfma_f32_16x16x32_bf16 v[20:23], a[100:103], v[32:35], v[20:23]
  v_mfma_f32_16x16x32_bf16 v[24:27], a[104:107], v[32:35], v[24:27]
  v_mfma_f32_16x16x32_bf16 v[28:31], a[108:111], v[32:35], v[28:31]
  s_waitcnt lgkmcnt(15)
  v_mfma_f32_16x16x32_bf16 v[20:23], a[112:115], v[32:35], v[20:23]
  v_mfma_f32_16x16x32_bf16 v[24:27], a[116:119], v[32:35], v[24:27]
  v_mfma_f32_16x16x32_bf16 v[28:31], a[120:123], v[32:35], v[28:31]
  s_waitcnt lgkmcnt(13)
  v_mfma_f32_16x16x32_bf16 v[20:23], a[124:127], v[32:35], v[20:23]
  v_mfma_f32_16x16x32_bf16 v[24:27], a[128:131], v[32:35], v[24:27]
  v_mfma_f32_16x16x32_bf16 v[28:31], a[132:135], v[32:35], v[28:31]
  s_waitcnt lgkmcnt(7)
  v_mfma_f32_16x16x32_bf16 v[20:23], a[136:139], v[32:35], v[20:23]
  v_mfma_f32_16x16x32_bf16 v[24:27], a[140:143], v[32:35], v[24:27]
  v_mfma_f32_16x16x32_bf16 v[28:31], a[144:147], v[32:35], v[28:31]
  s_add_u32 s51, s50, 23011328
  buffer_load_dwordx4 a[176:179], v6, s[8:11], s51 offen offset:2048 sc1
  buffer_load_dwordx4 a[180:183], v6, s[8:11], s51 offen offset:3072 sc1
  buffer_load_dwordx4 a[184:187], v7, s[8:11], s51 offen offset:0 sc1
  s_add_u32 s51, s50, 23052288
  buffer_load_dwordx4 a[188:191], v6, s[8:11], s51 offen offset:0 sc1
  buffer_load_dwordx4 a[192:195], v6, s[8:11], s51 offen offset:1024 sc1
  buffer_load_dwordx4 a[196:199], v6, s[8:11], s51 offen offset:2048 sc1
  s_waitcnt vmcnt(13)
  ds_read_b128 v[112:115], v212 offset:0
  ds_read_b128 v[116:119], v212 offset:1024
  ds_read_b128 v[120:123], v212 offset:2048
  ds_read_b128 v[124:127], v212 offset:3072
  ds_read_b128 v[128:131], v212 offset:4096
  s_waitcnt lgkmcnt(0)
  v_max3_u32 v0, v112, v115, 0
  v_max3_u32 v0, v116, v119, v0
  v_max3_u32 v0, v120, v123, v0
  v_max3_u32 v0, v124, v127, v0
  v_max3_u32 v0, v128, v131, v0
  v_cmp_eq_u32 vcc, -1, v0
  s_cbranch_vccnz Lretry15
Lresume16:
  s_waitcnt lgkmcnt(0)
  s_barrier
  ds_read_b128 v[112:115], v2 offset:0
  ds_read_b128 v[116:119], v2 offset:1024
  ds_read_b128 v[120:123], v2 offset:2048
  ds_read_b128 v[124:127], v2 offset:3072
  ds_read_b128 v[128:131], v2 offset:4096
  ds_read_b128 v[52:55], v2 offset:5120
  s_waitcnt lgkmcnt(4)
  v_mfma_f32_16x16x32_bf16 v[32:35], a[200:203], v[112:115], 0
  s_mov_b32 m0, s76
  v_mfma_f32_16x16x32_bf16 v[36:39], a[204:207], v[112:115], 0
  buffer_load_dwordx4 v2, s[8:11], s62 offen offset:0 sc1 lds
  v_mfma_f32_16x16x32_bf16 v[40:43], a[208:211], v[112:115], 0
  ds_read_b128 v[56:59], v2 offset:6144
  v_mfma_f32_16x16x32_bf16 v[32:35], a[212:215], v[116:119], v[32:35]
  buffer_load_dwordx4 v2, s[8:11], s62 offen offset:1024 sc1 lds
  v_mfma_f32_16x16x32_bf16 v[36:39], a[216:219], v[116:119], v[36:39]
  v_mfma_f32_16x16x32_bf16 v[40:43], a[220:223], v[116:119], v[40:43]
  ds_read_b128 v[60:63], v2 offset:7168
  s_waitcnt lgkmcnt(4)
  v_mfma_f32_16x16x32_bf16 v[32:35], a[224:227], v[120:123], v[32:35]
  buffer_load_dwordx4 v2, s[8:11], s62 offen offset:2048 sc1 lds
  v_mfma_f32_16x16x32_bf16 v[36:39], a[228:231], v[120:123], v[36:39]
  v_mfma_f32_16x16x32_bf16 v[40:43], a[232:235], v[120:123], v[40:43]
  buffer_load_dwordx4 v2, s[8:11], s62 offen offset:3072 sc1 lds
  ds_read_b128 v[64:67], v2 offset:8192
  v_mfma_f32_16x16x32_bf16 v[32:35], a[236:239], v[124:127], v[32:35]
  v_mfma_f32_16x16x32_bf16 v[36:39], a[240:243], v[124:127], v[36:39]
  s_addk_i32 m0, 2048
  v_mfma_f32_16x16x32_bf16 v[40:43], a[244:247], v[124:127], v[40:43]
  buffer_load_dwordx4 v17, s[8:11], s62 offen offset:2048 sc1 lds
  ds_read_b128 v[68:71], v2 offset:9216
  s_waitcnt lgkmcnt(4)
  v_mfma_f32_16x16x32_bf16 v[32:35], a[248:251], v[128:131], v[32:35]
  v_mfma_f32_16x16x32_bf16 v[36:39], a[252:255], v[128:131], v[36:39]
  s_waitcnt vmcnt(11)
  ds_read_b128 v[132:135], v213 offset:0
  ds_read_b128 v[136:139], v213 offset:1024
  ds_read_b128 v[140:143], v213 offset:2048
  v_mfma_f32_16x16x32_bf16 v[40:43], v[216:219], v[128:131], v[40:43]
  ds_read_b128 v[144:147], v213 offset:3072
  ds_read_b128 v[148:151], v213 offset:4096
  s_waitcnt lgkmcnt(0)
  ds_read_b128 v[112:115], v2 offset:10240
  v_mfma_f32_16x16x32_bf16 v[32:35], v[220:223], v[52:55], v[32:35]
  v_max3_u32 v0, v132, v135, 0
  v_max3_u32 v0, v136, v139, v0
  v_max3_u32 v0, v140, v143, v0
  v_mfma_f32_16x16x32_bf16 v[36:39], v[224:227], v[52:55], v[36:39]
  v_max3_u32 v0, v144, v147, v0
  v_max3_u32 v0, v148, v151, v0
  v_cmp_eq_u32 vcc, -1, v0
  s_cbranch_vccnz Lretry17
Lresume18:
  v_mfma_f32_16x16x32_bf16 v[40:43], v[228:231], v[52:55], v[40:43]
  s_waitcnt vmcnt(16)
  v_max3_u32 v0, v76, v78, 0
  ds_read_b128 v[116:119], v2 offset:11264
  s_waitcnt lgkmcnt(9)
  v_mfma_f32_16x16x32_bf16 v[32:35], v[232:235], v[56:59], v[32:35]
  v_cmp_eq_u32 vcc, -1, v0
  s_cbranch_vccnz Lretry19
Lresume20:
  v_add_f32 v83, v76, v78
  v_lshlrev_b32 v84, 4, v4
  v_mfma_f32_16x16x32_bf16 v[36:39], v[236:239], v[56:59], v[36:39]
  v_mov_b32 v80, v83
  s_nop 1
  v_permlane16_swap_b32 v83, v80
  v_add_f32 v83, v83, v80
  v_mfma_f32_16x16x32_bf16 v[40:43], v[240:243], v[56:59], v[40:43]
  v_add_u32 v84, 86016, v84
  v_mov_b32 v80, v83
  s_nop 1
  v_permlane32_swap_b32 v83, v80
  ds_read_b128 v[120:123], v2 offset:12288
  v_mfma_f32_16x16x32_bf16 v[32:35], v[244:247], v[60:63], v[32:35]
  v_add_f32 v83, v83, v80
  v_mul_f32 v83, 0xbe000000, v83
  v_add_f32 v76, v76, v83
  v_add_f32 v78, v78, v83
  v_mfma_f32_16x16x32_bf16 v[36:39], v[248:251], v[60:63], v[36:39]
  v_mul_f32 v82, v76, v76
  v_fmac_f32 v82, v78, v78
  v_add_f32 v77, v77, v79
  v_mfma_f32_16x16x32_bf16 v[40:43], v[252:255], v[60:63], v[40:43]
  v_fmamk_f32 v82, v82, 0x42a00000, v77
  s_lshl_b32 s55, s3, 8
  ds_read_b128 v[124:127], v2 offset:13312
  s_waitcnt lgkmcnt(9)
  v_mfma_f32_16x16x32_bf16 v[32:35], a[0:3], v[64:67], v[32:35]
  v_mov_b32 v80, v82
  s_nop 1
  v_permlane16_swap_b32 v82, v80
  v_add_f32 v82, v82, v80
  v_add_u32 v85, s55, v84
  v_mfma_f32_16x16x32_bf16 v[36:39], a[4:7], v[64:67], v[36:39]
  v_mov_b32 v80, v82
  s_nop 1
  v_permlane32_swap_b32 v82, v80
  v_add_f32 v82, v82, v80
  v_mov_b32 v76, 0x3727c5ac
  v_mfma_f32_16x16x32_bf16 v[40:43], a[8:11], v[64:67], v[40:43]
  v_fmac_f32 v76, 0x3acccccd, v82
  v_rsq_f32 v77, v76
  ds_read_b128 v[128:131], v2 offset:14336
  v_mfma_f32_16x16x32_bf16 v[32:35], a[12:15], v[68:71], v[32:35]
  s_nop 0
  v_mul_f32 v82, v76, v77
  v_mul_f32 v80, 0xc0135761, v77
  v_mfma_f32_16x16x32_bf16 v[36:39], a[16:19], v[68:71], v[36:39]
  v_mul_f32 v81, v77, v77
  v_mul_f32 v81, v81, v77
  v_mul_f32 v81, 0xbdd2d3e8, v81
  ds_write_b128 v85, v[80:83]
  v_mfma_f32_16x16x32_bf16 v[40:43], a[20:23], v[68:71], v[40:43]
  s_mov_b32 m0, s77
  ds_read_b128 v[52:55], v74 offset:0
  s_waitcnt lgkmcnt(5)
  v_mfma_f32_16x16x32_bf16 v[32:35], a[24:27], v[112:115], v[32:35]
  buffer_load_dwordx4 v2, s[8:11], s63 offen offset:0 sc1 lds
  v_mfma_f32_16x16x32_bf16 v[36:39], a[28:31], v[112:115], v[36:39]
  v_mfma_f32_16x16x32_bf16 v[40:43], a[32:35], v[112:115], v[40:43]
  ds_read_b128 v[56:59], v74 offset:1024
  v_mfma_f32_16x16x32_bf16 v[32:35], a[36:39], v[116:119], v[32:35]
  buffer_load_dwordx4 v2, s[8:11], s63 offen offset:1024 sc1 lds
  v_mfma_f32_16x16x32_bf16 v[36:39], a[40:43], v[116:119], v[36:39]
  v_mfma_f32_16x16x32_bf16 v[40:43], a[44:47], v[116:119], v[40:43]
  ds_read_b128 v[60:63], v74 offset:2048
  s_waitcnt lgkmcnt(5)
  v_mfma_f32_16x16x32_bf16 v[32:35], a[48:51], v[120:123], v[32:35]
  buffer_load_dwordx4 v2, s[8:11], s63 offen offset:2048 sc1 lds
  v_mfma_f32_16x16x32_bf16 v[36:39], a[52:55], v[120:123], v[36:39]
  v_mfma_f32_16x16x32_bf16 v[40:43], a[56:59], v[120:123], v[40:43]
  buffer_load_dwordx4 v2, s[8:11], s63 offen offset:3072 sc1 lds
  ds_read_b128 v[64:67], v74 offset:3072
  v_mfma_f32_16x16x32_bf16 v[32:35], a[60:63], v[124:127], v[32:35]
  s_addk_i32 m0, 2048
  v_mfma_f32_16x16x32_bf16 v[36:39], a[64:67], v[124:127], v[36:39]
  buffer_load_dwordx4 v17, s[8:11], s63 offen offset:2048 sc1 lds
  v_mfma_f32_16x16x32_bf16 v[40:43], a[68:71], v[124:127], v[40:43]
  s_waitcnt lgkmcnt(4)
  s_barrier
  ds_read_b128 v[68:71], v74 offset:4096
  s_waitcnt lgkmcnt(4)
  v_mfma_f32_16x16x32_bf16 v[32:35], a[72:75], v[128:131], v[32:35]
  ds_read_b128 v[92:95], v84 offset:0
  ds_read_b128 v[96:99], v84 offset:256
  ds_read_b128 v[100:103], v84 offset:512
  ds_read_b128 v[104:107], v84 offset:768
  v_mfma_f32_16x16x32_bf16 v[36:39], a[76:79], v[128:131], v[36:39]
  s_waitcnt vmcnt(5)
  ds_read_b128 v[152:155], v214 offset:0
  ds_read_b128 v[156:159], v214 offset:1024
  ds_read_b128 v[160:163], v214 offset:2048
  ds_read_b128 v[164:167], v214 offset:3072
  v_mfma_f32_16x16x32_bf16 v[40:43], a[80:83], v[128:131], v[40:43]
  ds_read_b128 v[112:115], v2 offset:15360
  s_add_u32 s51, s50, 23134208
  s_add_u32 m0, s47, 5120
  s_nop 0
  buffer_load_dwordx4 v7, s[8:11], s51 offen offset:0 sc1 lds
  v_mfma_f32_16x16x32_bf16 v[32:35], a[84:87], v[52:55], v[32:35]
  v_mfma_f32_16x16x32_bf16 v[36:39], a[88:91], v[52:55], v[36:39]
  ds_read_b128 v[168:171], v214 offset:4096
  s_waitcnt lgkmcnt(0)
  v_mfma_f32_16x16x32_bf16 v[40:43], a[92:95], v[52:55], v[40:43]
  ds_read_b128 v[116:119], v2 offset:16384
  s_add_u32 s51, s50, 23175168
  s_add_u32 m0, s47, 6144
  s_nop 0
  buffer_load_dwordx4 v6, s[8:11], s51 offen offset:0 sc1 lds
  s_waitcnt lgkmcnt(13)
  v_mfma_f32_16x16x32_bf16 v[32:35], a[100:103], v[56:59], v[32:35]
  v_mfma_f32_16x16x32_bf16 v[36:39], a[104:107], v[56:59], v[36:39]
  v_max3_u32 v0, v152, v155, 0
  v_mfma_f32_16x16x32_bf16 v[40:43], a[108:111], v[56:59], v[40:43]
  ds_read_b128 v[120:123], v2 offset:17408
  buffer_load_dwordx4 v6, s[8:11], s51 offen offset:1024 sc1 lds
  v_mfma_f32_16x16x32_bf16 v[32:35], a[112:115], v[60:63], v[32:35]
  v_mfma_f32_16x16x32_bf16 v[36:39], a[116:119], v[60:63], v[36:39]
  v_max3_u32 v0, v156, v159, v0
  v_max3_u32 v0, v160, v163, v0
  v_max3_u32 v0, v164, v167, v0
  v_max3_u32 v0, v168, v171, v0
  v_mfma_f32_16x16x32_bf16 v[40:43], a[120:123], v[60:63], v[40:43]
  ds_read_b128 v[124:127], v2 offset:18432
  buffer_load_dwordx4 v6, s[8:11], s51 offen offset:2048 sc1 lds
  s_waitcnt lgkmcnt(13)
  v_mfma_f32_16x16x32_bf16 v[32:35], a[124:127], v[64:67], v[32:35]
  v_mfma_f32_16x16x32_bf16 v[36:39], a[128:131], v[64:67], v[36:39]
  v_cmp_eq_u32 vcc, -1, v0
  s_cbranch_vccnz Lretry21
Lresume22:
  v_mfma_f32_16x16x32_bf16 v[40:43], a[132:135], v[64:67], v[40:43]
  ds_read_b128 v[128:131], v2 offset:19456
  buffer_load_dwordx4 v6, s[8:11], s51 offen offset:3072 sc1 lds
  v_mfma_f32_16x16x32_bf16 v[32:35], a[136:139], v[68:71], v[32:35]
  v_mfma_f32_16x16x32_bf16 v[36:39], a[140:143], v[68:71], v[36:39]
  v_mfma_f32_16x16x32_bf16 v[40:43], a[144:147], v[68:71], v[40:43]
  ds_read_b128 v[132:135], v2 offset:20480
  s_add_u32 m0, s47, 10240
  s_nop 0
  buffer_load_dwordx4 v7, s[8:11], s51 offen offset:0 sc1 lds
  s_waitcnt lgkmcnt(4)
  v_mfma_f32_16x16x32_bf16 v[44:47], a[200:203], v[112:115], 0
  v_mfma_f32_16x16x32_bf16 v[48:51], a[204:207], v[112:115], 0
  v_mfma_f32_16x16x32_bf16 v[52:55], a[208:211], v[112:115], 0
  ds_read_b128 v[136:139], v2 offset:21504
  v_mfma_f32_16x16x32_bf16 v[44:47], a[212:215], v[116:119], v[44:47]
  s_waitcnt lgkmcnt(12)
  v_fmac_f32 v32, v20, v95
  v_fmac_f32 v33, v21, v95
  v_fmac_f32 v34, v22, v95
  v_mfma_f32_16x16x32_bf16 v[48:51], a[216:219], v[116:119], v[48:51]
  v_fmac_f32 v35, v23, v95
  v_fmac_f32 v36, v24, v95
  v_fmac_f32 v37, v25, v95
  v_fmac_f32 v38, v26, v95
  v_mfma_f32_16x16x32_bf16 v[52:55], a[220:223], v[116:119], v[52:55]
  v_fmac_f32 v39, v27, v95
  v_fmac_f32 v40, v28, v95
  ds_read_b128 v[140:143], v2 offset:22528
  s_waitcnt lgkmcnt(4)
  v_mfma_f32_16x16x32_bf16 v[44:47], a[224:227], v[120:123], v[44:47]
  v_fmac_f32 v41, v29, v95
  v_fmac_f32 v42, v30, v95
  v_fmac_f32 v43, v31, v95
  v_mul_f32 v56, v32, v32
  v_mul_f32 v57, v33, v33
  v_mfma_f32_16x16x32_bf16 v[48:51], a[228:231], v[120:123], v[48:51]
  v_mul_f32 v58, v34, v34
  v_mul_f32 v59, v35, v35
  v_mul_f32 v60, v36, v36
  v_mul_f32 v61, v37, v37
  v_mfma_f32_16x16x32_bf16 v[52:55], a[232:235], v[120:123], v[52:55]
  ds_read_b128 v[144:147], v2 offset:23552
  s_add_u32 s51, s50, 23216128
  s_add_u32 m0, s47, 11264
  s_nop 0
  buffer_load_dwordx4 v6, s[8:11], s51 offen offset:0 sc1 lds
  v_mfma_f32_16x16x32_bf16 v[44:47], a[236:239], v[124:127], v[44:47]
  v_mfma_f32_16x16x32_bf16 v[48:51], a[240:243], v[124:127], v[48:51]
  v_mul_f32 v62, v38, v38
  v_mfma_f32_16x16x32_bf16 v[52:55], a[244:247], v[124:127], v[52:55]
  ds_read_b128 v[148:151], v2 offset:24576
  buffer_load_dwordx4 v6, s[8:11], s51 offen offset:1024 sc1 lds
  s_waitcnt lgkmcnt(4)
  v_mfma_f32_16x16x32_bf16 v[44:47], a[248:251], v[128:131], v[44:47]
  v_mfma_f32_16x16x32_bf16 v[48:51], a[252:255], v[128:131], v[48:51]
  v_mul_f32 v63, v39, v39
  v_mul_f32 v64, v40, v40
  v_mfma_f32_16x16x32_bf16 v[52:55], v[216:219], v[128:131], v[52:55]
  v_mul_f32 v65, v41, v41
  v_mul_f32 v66, v42, v42
  v_mul_f32 v67, v43, v43
  v_fma_f32 v56, v56, v93, v92
  ds_read_b128 v[112:115], v2 offset:25600
  v_mfma_f32_16x16x32_bf16 v[44:47], v[220:223], v[132:135], v[44:47]
  v_fma_f32 v57, v57, v93, v92
  v_fma_f32 v58, v58, v93, v92
  v_fma_f32 v59, v59, v93, v92
  v_fma_f32 v60, v60, v93, v92
  v_mfma_f32_16x16x32_bf16 v[48:51], v[224:227], v[132:135], v[48:51]
  v_fma_f32 v61, v61, v93, v92
  v_fma_f32 v62, v62, v93, v92
  v_fma_f32 v63, v63, v93, v92
  v_fma_f32 v64, v64, v93, v92
  v_mfma_f32_16x16x32_bf16 v[52:55], v[228:231], v[132:135], v[52:55]
  ds_read_b128 v[116:119], v2 offset:26624
  buffer_load_dwordx4 v6, s[8:11], s51 offen offset:2048 sc1 lds
  s_waitcnt lgkmcnt(4)
  v_mfma_f32_16x16x32_bf16 v[44:47], v[232:235], v[136:139], v[44:47]
  v_mfma_f32_16x16x32_bf16 v[48:51], v[236:239], v[136:139], v[48:51]
  v_fma_f32 v65, v65, v93, v92
  v_fma_f32 v66, v66, v93, v92
  v_mfma_f32_16x16x32_bf16 v[52:55], v[240:243], v[136:139], v[52:55]
  ds_read_b128 v[120:123], v2 offset:27648
  buffer_load_dwordx4 v6, s[8:11], s51 offen offset:3072 sc1 lds
  v_mfma_f32_16x16x32_bf16 v[44:47], v[244:247], v[140:143], v[44:47]
  v_mfma_f32_16x16x32_bf16 v[48:51], v[248:251], v[140:143], v[48:51]
  v_fma_f32 v67, v67, v93, v92
  v_mul_f32 v56, v56, v32
  v_mul_f32 v57, v57, v33
  v_mul_f32 v58, v58, v34
  v_mfma_f32_16x16x32_bf16 v[52:55], v[252:255], v[140:143], v[52:55]
  v_mul_f32 v59, v59, v35
  v_mul_f32 v60, v60, v36
  ds_read_b128 v[124:127], v2 offset:28672
  s_waitcnt lgkmcnt(4)
  v_mfma_f32_16x16x32_bf16 v[44:47], a[0:3], v[144:147], v[44:47]
  v_mul_f32 v61, v61, v37
  s_waitcnt vmcnt(10)
  ds_read_b128 v[172:175], v215 offset:0
  ds_read_b128 v[176:179], v215 offset:1024
  v_mfma_f32_16x16x32_bf16 v[48:51], a[4:7], v[144:147], v[48:51]
  ds_read_b128 v[180:183], v215 offset:2048
  ds_read_b128 v[184:187], v215 offset:3072
  ds_read_b128 v[188:191], v215 offset:4096
  s_waitcnt lgkmcnt(0)
  v_mfma_f32_16x16x32_bf16 v[52:55], a[8:11], v[144:147], v[52:55]
  ds_read_b128 v[128:131], v2 offset:29696
  s_add_u32 m0, s47, 15360
  s_nop 0
  buffer_load_dwordx4 v7, s[8:11], s51 offen offset:0 sc1 lds
  v_mfma_f32_16x16x32_bf16 v[44:47], a[12:15], v[148:151], v[44:47]
  v_mfma_f32_16x16x32_bf16 v[48:51], a[16:19], v[148:151], v[48:51]
  v_max3_u32 v0, v172, v175, 0
  v_max3_u32 v0, v176, v179, v0
  v_mfma_f32_16x16x32_bf16 v[52:55], a[20:23], v[148:151], v[52:55]
  ds_read_b128 v[132:135], v75 offset:0
  s_add_u32 s51, s50, 23257088
  s_add_u32 m0, s47, 16384
  s_nop 0
  buffer_load_dwordx4 v6, s[8:11], s51 offen offset:0 sc1 lds
  s_waitcnt lgkmcnt(9)
  v_mfma_f32_16x16x32_bf16 v[44:47], a[24:27], v[112:115], v[44:47]
  v_mfma_f32_16x16x32_bf16 v[48:51], a[28:31], v[112:115], v[48:51]
  v_max3_u32 v0, v180, v183, v0
  v_mfma_f32_16x16x32_bf16 v[52:55], a[32:35], v[112:115], v[52:55]
  v_max3_u32 v0, v184, v187, v0
  v_max3_u32 v0, v188, v191, v0
  v_cmp_eq_u32 vcc, -1, v0
  s_cbranch_vccnz Lretry23
Lresume24:
  s_waitcnt lgkmcnt(2)
  s_barrier
  ds_read_b128 v[136:139], v75 offset:1024
  v_mfma_f32_16x16x32_bf16 v[44:47], a[36:39], v[116:119], v[44:47]
  v_mul_f32 v62, v62, v38
  v_mul_f32 v63, v63, v39
  v_mul_f32 v64, v64, v40
  v_mul_f32 v65, v65, v41
  v_mul_f32 v66, v66, v42
  v_mul_f32 v67, v67, v43
  v_mfma_f32_16x16x32_bf16 v[48:51], a[40:43], v[116:119], v[48:51]
  v_exp_f32 v56, v56
  v_exp_f32 v57, v57
  v_exp_f32 v58, v58
  v_mfma_f32_16x16x32_bf16 v[52:55], a[44:47], v[116:119], v[52:55]
  ds_read_b128 v[140:143], v75 offset:2048
  buffer_load_dwordx4 v6, s[8:11], s51 offen offset:1024 sc1 lds
  s_waitcnt lgkmcnt(9)
  v_mfma_f32_16x16x32_bf16 v[44:47], a[48:51], v[120:123], v[44:47]
  v_exp_f32 v59, v59
  v_mfma_f32_16x16x32_bf16 v[48:51], a[52:55], v[120:123], v[48:51]
  v_exp_f32 v60, v60
  v_exp_f32 v61, v61
  v_exp_f32 v62, v62
  v_mfma_f32_16x16x32_bf16 v[52:55], a[56:59], v[120:123], v[52:55]
  v_exp_f32 v63, v63
  v_exp_f32 v64, v64
  v_exp_f32 v65, v65
  ds_read_b128 v[144:147], v75 offset:3072
  v_mfma_f32_16x16x32_bf16 v[44:47], a[60:63], v[124:127], v[44:47]
  v_exp_f32 v66, v66
  v_exp_f32 v67, v67
  v_fma_f32 v56, v56, v94, v94
  v_mfma_f32_16x16x32_bf16 v[48:51], a[64:67], v[124:127], v[48:51]
  v_fma_f32 v57, v57, v94, v94
  v_fma_f32 v58, v58, v94, v94
  v_fma_f32 v59, v59, v94, v94
  v_fma_f32 v60, v60, v94, v94
  v_fma_f32 v61, v61, v94, v94
  v_fma_f32 v62, v62, v94, v94
  v_mfma_f32_16x16x32_bf16 v[52:55], a[68:71], v[124:127], v[52:55]
  ds_read_b128 v[148:151], v75 offset:4096
  buffer_load_dwordx4 v6, s[8:11], s51 offen offset:2048 sc1 lds
  s_waitcnt lgkmcnt(4)
  v_mfma_f32_16x16x32_bf16 v[44:47], a[72:75], v[128:131], v[44:47]
  v_fma_f32 v63, v63, v94, v94
  v_fma_f32 v64, v64, v94, v94
  v_mfma_f32_16x16x32_bf16 v[48:51], a[76:79], v[128:131], v[48:51]
  v_fma_f32 v65, v65, v94, v94
  v_fma_f32 v66, v66, v94, v94
  v_fma_f32 v67, v67, v94, v94
  v_rcp_f32 v56, v56
  v_rcp_f32 v57, v57
  v_mfma_f32_16x16x32_bf16 v[52:55], a[80:83], v[128:131], v[52:55]
  ds_read_b128 v[112:115], v2 offset:30720
  buffer_load_dwordx4 v6, s[8:11], s51 offen offset:3072 sc1 lds
  v_mfma_f32_16x16x32_bf16 v[44:47], a[84:87], v[132:135], v[44:47]
  v_rcp_f32 v58, v58
  v_mfma_f32_16x16x32_bf16 v[48:51], a[88:91], v[132:135], v[48:51]
  v_rcp_f32 v59, v59
  v_rcp_f32 v60, v60
  v_rcp_f32 v61, v61
  v_mfma_f32_16x16x32_bf16 v[52:55], a[92:95], v[132:135], v[52:55]
  v_rcp_f32 v62, v62
  v_rcp_f32 v63, v63
  ds_read_b128 v[116:119], v2 offset:31744
  s_waitcnt lgkmcnt(4)
  v_mfma_f32_16x16x32_bf16 v[44:47], a[100:103], v[136:139], v[44:47]
  v_rcp_f32 v64, v64
  v_rcp_f32 v65, v65
  v_rcp_f32 v66, v66
  v_mfma_f32_16x16x32_bf16 v[48:51], a[104:107], v[136:139], v[48:51]
  v_rcp_f32 v67, v67
  v_mul_f32 v32, v32, v56
  v_mul_f32 v33, v33, v57
  v_mul_f32 v34, v34, v58
  v_mul_f32 v35, v35, v59
  v_mfma_f32_16x16x32_bf16 v[52:55], a[108:111], v[136:139], v[52:55]
  ds_read_b128 v[120:123], v2 offset:32768
  s_add_u32 m0, s47, 20480
  s_nop 0
  buffer_load_dwordx4 v7, s[8:11], s51 offen offset:0 sc1 lds
  v_mfma_f32_16x16x32_bf16 v[44:47], a[112:115], v[140:143], v[44:47]
  v_mul_f32 v36, v36, v60
  v_mul_f32 v37, v37, v61
  v_mfma_f32_16x16x32_bf16 v[48:51], a[116:119], v[140:143], v[48:51]
  v_mul_f32 v38, v38, v62
  v_mul_f32 v39, v39, v63
  v_mul_f32 v40, v40, v64
  v_mul_f32 v41, v41, v65
  v_mul_f32 v42, v42, v66
  v_mul_f32 v43, v43, v67
  v_mfma_f32_16x16x32_bf16 v[52:55], a[120:123], v[140:143], v[52:55]
  ds_read_b128 v[124:127], v2 offset:33792
  s_add_u32 s51, s50, 23298048
  s_add_u32 m0, s47, 21504
  s_nop 0
  buffer_load_dwordx4 v6, s[8:11], s51 offen offset:0 sc1 lds
  s_waitcnt lgkmcnt(4)
  v_mfma_f32_16x16x32_bf16 v[44:47], a[124:127], v[144:147], v[44:47]
  v_mfma_f32_16x16x32_bf16 v[48:51], a[128:131], v[144:147], v[48:51]
  v_cvt_pk_bf16_f32 v68, v32, v33
  v_cvt_pk_bf16_f32 v69, v34, v35
  v_cvt_pk_bf16_f32 v70, v36, v37
  v_cvt_pk_bf16_f32 v71, v38, v39
  v_cvt_pk_bf16_f32 v72, v40, v41
  v_cvt_pk_bf16_f32 v73, v42, v43
  v_mfma_f32_16x16x32_bf16 v[52:55], a[132:135], v[144:147], v[52:55]
  s_add_u32 s53, s66, 0
  s_add_u32 s54, s67, 0
  v_permlane16_swap_b32 v68, v70
  v_permlane16_swap_b32 v69, v71
  ds_read_b128 v[128:131], v2 offset:34816
  v_mfma_f32_16x16x32_bf16 v[44:47], a[136:139], v[148:151], v[44:47]
  buffer_store_dwordx2 v[72:73], v19, s[8:11], s54 offen sc1
  v_mfma_f32_16x16x32_bf16 v[48:51], a[140:143], v[148:151], v[48:51]
  buffer_store_dwordx4 v[68:71], v18, s[8:11], s53 offen sc1
  v_mfma_f32_16x16x32_bf16 v[52:55], a[144:147], v[148:151], v[52:55]
  ds_read_b128 v[132:135], v2 offset:35840
  buffer_load_dwordx4 v6, s[8:11], s51 offen offset:1024 sc1 lds
  s_waitcnt lgkmcnt(4)
  v_mfma_f32_16x16x32_bf16 v[32:35], a[200:203], v[112:115], 0
  v_mfma_f32_16x16x32_bf16 v[36:39], a[204:207], v[112:115], 0
  v_mfma_f32_16x16x32_bf16 v[40:43], a[208:211], v[112:115], 0
  ds_read_b128 v[136:139], v2 offset:36864
  buffer_load_dwordx4 v6, s[8:11], s51 offen offset:2048 sc1 lds
  v_mfma_f32_16x16x32_bf16 v[32:35], a[212:215], v[116:119], v[32:35]
  v_fmac_f32 v44, v20, v99
  v_fmac_f32 v45, v21, v99
  v_fmac_f32 v46, v22, v99
  v_fmac_f32 v47, v23, v99
  v_fmac_f32 v48, v24, v99
  v_mfma_f32_16x16x32_bf16 v[36:39], a[216:219], v[116:119], v[36:39]
  v_fmac_f32 v49, v25, v99
  v_fmac_f32 v50, v26, v99
  v_fmac_f32 v51, v27, v99
  v_fmac_f32 v52, v28, v99
  v_mfma_f32_16x16x32_bf16 v[40:43], a[220:223], v[116:119], v[40:43]
  v_fmac_f32 v53, v29, v99
  v_fmac_f32 v54, v30, v99
  v_fmac_f32 v55, v31, v99
  ds_read_b128 v[140:143], v2 offset:37888
  s_waitcnt lgkmcnt(4)
  v_mfma_f32_16x16x32_bf16 v[32:35], a[224:227], v[120:123], v[32:35]
  v_mul_f32 v56, v44, v44
  v_mul_f32 v57, v45, v45
  v_mul_f32 v58, v46, v46
  v_mul_f32 v59, v47, v47
  v_mul_f32 v60, v48, v48
  v_mfma_f32_16x16x32_bf16 v[36:39], a[228:231], v[120:123], v[36:39]
  v_mul_f32 v61, v49, v49
  v_mul_f32 v62, v50, v50
  v_mul_f32 v63, v51, v51
  v_mul_f32 v64, v52, v52
  v_mul_f32 v65, v53, v53
  v_mfma_f32_16x16x32_bf16 v[40:43], a[232:235], v[120:123], v[40:43]
  ds_read_b128 v[144:147], v2 offset:38912
  buffer_load_dwordx4 v6, s[8:11], s51 offen offset:3072 sc1 lds
  v_mfma_f32_16x16x32_bf16 v[32:35], a[236:239], v[124:127], v[32:35]
  v_mfma_f32_16x16x32_bf16 v[36:39], a[240:243], v[124:127], v[36:39]
  v_mul_f32 v66, v54, v54
  v_mul_f32 v67, v55, v55
  v_fma_f32 v56, v56, v97, v96
  v_fma_f32 v57, v57, v97, v96
  v_fma_f32 v58, v58, v97, v96
  v_mfma_f32_16x16x32_bf16 v[40:43], a[244:247], v[124:127], v[40:43]
  v_fma_f32 v59, v59, v97, v96
  v_fma_f32 v60, v60, v97, v96
  ds_read_b128 v[148:151], v2 offset:39936
  s_waitcnt lgkmcnt(4)
  v_mfma_f32_16x16x32_bf16 v[32:35], a[248:251], v[128:131], v[32:35]
  v_fma_f32 v61, v61, v97, v96
  v_fma_f32 v62, v62, v97, v96
  v_fma_f32 v63, v63, v97, v96
  v_fma_f32 v64, v64, v97, v96
  v_fma_f32 v65, v65, v97, v96
  v_mfma_f32_16x16x32_bf16 v[36:39], a[252:255], v[128:131], v[36:39]
  v_fma_f32 v66, v66, v97, v96
  v_fma_f32 v67, v67, v97, v96
  v_mul_f32 v56, v56, v44
  v_mul_f32 v57, v57, v45
  v_mul_f32 v58, v58, v46
  v_mfma_f32_16x16x32_bf16 v[40:43], v[216:219], v[128:131], v[40:43]
  ds_read_b128 v[112:115], v2 offset:40960
  s_add_u32 s51, s50, 23052288
  buffer_load_dwordx4 v[152:155], v7, s[8:11], s51 offen offset:0 sc1
  v_mfma_f32_16x16x32_bf16 v[32:35], v[220:223], v[132:135], v[32:35]
  v_mul_f32 v59, v59, v47
  v_mul_f32 v60, v60, v48
  v_mfma_f32_16x16x32_bf16 v[36:39], v[224:227], v[132:135], v[36:39]
  v_mul_f32 v61, v61, v49
  v_mul_f32 v62, v62, v50
  v_mul_f32 v63, v63, v51
  v_mul_f32 v64, v64, v52
  v_mul_f32 v65, v65, v53
  v_mfma_f32_16x16x32_bf16 v[40:43], v[228:231], v[132:135], v[40:43]
  ds_read_b128 v[116:119], v2 offset:41984
  s_add_u32 s51, s50, 23093248
  buffer_load_dwordx4 v[156:159], v6, s[8:11], s51 offen offset:0 sc1
  s_waitcnt lgkmcnt(4)
  v_mfma_f32_16x16x32_bf16 v[32:35], v[232:235], v[136:139], v[32:35]
  v_mul_f32 v66, v66, v54
  v_mfma_f32_16x16x32_bf16 v[36:39], v[236:239], v[136:139], v[36:39]
  v_mul_f32 v67, v67, v55
  v_exp_f32 v56, v56
  v_exp_f32 v57, v57
  v_mfma_f32_16x16x32_bf16 v[40:43], v[240:243], v[136:139], v[40:43]
  ds_read_b128 v[120:123], v2 offset:43008
  buffer_load_dwordx4 v[160:163], v6, s[8:11], s51 offen offset:1024 sc1
  v_mfma_f32_16x16x32_bf16 v[32:35], v[244:247], v[140:143], v[32:35]
  v_exp_f32 v58, v58
  v_exp_f32 v59, v59
  v_mfma_f32_16x16x32_bf16 v[36:39], v[248:251], v[140:143], v[36:39]
  v_exp_f32 v60, v60
  v_exp_f32 v61, v61
  v_mfma_f32_16x16x32_bf16 v[40:43], v[252:255], v[140:143], v[40:43]
  v_exp_f32 v62, v62
  ds_read_b128 v[124:127], v2 offset:44032
  s_waitcnt lgkmcnt(4)
  v_mfma_f32_16x16x32_bf16 v[32:35], a[0:3], v[144:147], v[32:35]
  v_exp_f32 v63, v63
  v_exp_f32 v64, v64
  v_exp_f32 v65, v65
  v_mfma_f32_16x16x32_bf16 v[36:39], a[4:7], v[144:147], v[36:39]
  v_exp_f32 v66, v66
  v_exp_f32 v67, v67
  v_mfma_f32_16x16x32_bf16 v[40:43], a[8:11], v[144:147], v[40:43]
  ds_read_b128 v[128:131], v2 offset:45056
  buffer_load_dwordx4 v[164:167], v6, s[8:11], s51 offen offset:2048 sc1
  v_mfma_f32_16x16x32_bf16 v[32:35], a[12:15], v[148:151], v[32:35]
  v_fma_f32 v56, v56, v98, v98
  v_fma_f32 v57, v57, v98, v98
  v_fma_f32 v58, v58, v98, v98
  v_fma_f32 v59, v59, v98, v98
  v_mfma_f32_16x16x32_bf16 v[36:39], a[16:19], v[148:151], v[36:39]
  v_fma_f32 v60, v60, v98, v98
  v_fma_f32 v61, v61, v98, v98
  v_fma_f32 v62, v62, v98, v98
  v_fma_f32 v63, v63, v98, v98
  v_mfma_f32_16x16x32_bf16 v[40:43], a[20:23], v[148:151], v[40:43]
  ds_read_b128 v[132:135], v75 offset:25600
  buffer_load_dwordx4 v[168:171], v6, s[8:11], s51 offen offset:3072 sc1
  s_waitcnt lgkmcnt(4)
  v_mfma_f32_16x16x32_bf16 v[32:35], a[24:27], v[112:115], v[32:35]
  v_fma_f32 v64, v64, v98, v98
  v_fma_f32 v65, v65, v98, v98
  v_fma_f32 v66, v66, v98, v98
  v_mfma_f32_16x16x32_bf16 v[36:39], a[28:31], v[112:115], v[36:39]
  v_fma_f32 v67, v67, v98, v98
  v_rcp_f32 v56, v56
  v_rcp_f32 v57, v57
  v_mfma_f32_16x16x32_bf16 v[40:43], a[32:35], v[112:115], v[40:43]
  v_rcp_f32 v58, v58
  v_rcp_f32 v59, v59
  ds_read_b128 v[136:139], v75 offset:26624
  v_mfma_f32_16x16x32_bf16 v[32:35], a[36:39], v[116:119], v[32:35]
  v_rcp_f32 v60, v60
  v_rcp_f32 v61, v61
  v_mfma_f32_16x16x32_bf16 v[36:39], a[40:43], v[116:119], v[36:39]
  v_rcp_f32 v62, v62
  v_rcp_f32 v63, v63
  v_mfma_f32_16x16x32_bf16 v[40:43], a[44:47], v[116:119], v[40:43]
  ds_read_b128 v[140:143], v75 offset:27648
  buffer_load_dwordx4 v[172:175], v7, s[8:11], s51 offen offset:0 sc1
  s_waitcnt lgkmcnt(4)
  v_mfma_f32_16x16x32_bf16 v[32:35], a[48:51], v[120:123], v[32:35]
  v_rcp_f32 v64, v64
  v_mfma_f32_16x16x32_bf16 v[36:39], a[52:55], v[120:123], v[36:39]
  v_rcp_f32 v65, v65
  v_rcp_f32 v66, v66
  v_rcp_f32 v67, v67
  v_mfma_f32_16x16x32_bf16 v[40:43], a[56:59], v[120:123], v[40:43]
  ds_read_b128 v[144:147], v75 offset:28672
  s_add_u32 s51, s50, 23134208
  buffer_load_dwordx4 v[176:179], v6, s[8:11], s51 offen offset:0 sc1
  v_mfma_f32_16x16x32_bf16 v[32:35], a[60:63], v[124:127], v[32:35]
  v_mul_f32 v44, v44, v56
  v_mul_f32 v45, v45, v57
  v_mfma_f32_16x16x32_bf16 v[36:39], a[64:67], v[124:127], v[36:39]
  v_mul_f32 v46, v46, v58
  v_mul_f32 v47, v47, v59
  v_mul_f32 v48, v48, v60
  v_mul_f32 v49, v49, v61
  v_mul_f32 v50, v50, v62
  v_mfma_f32_16x16x32_bf16 v[40:43], a[68:71], v[124:127], v[40:43]
  ds_read_b128 v[148:151], v75 offset:29696
  buffer_load_dwordx4 v[180:183], v6, s[8:11], s51 offen offset:1024 sc1
  s_waitcnt lgkmcnt(4)
  v_mfma_f32_16x16x32_bf16 v[32:35], a[72:75], v[128:131], v[32:35]
  v_mul_f32 v51, v51, v63
  v_mul_f32 v52, v52, v64
  v_mfma_f32_16x16x32_bf16 v[36:39], a[76:79], v[128:131], v[36:39]
  v_mul_f32 v53, v53, v65
  v_mul_f32 v54, v54, v66
  v_mul_f32 v55, v55, v67
  v_cvt_pk_bf16_f32 v68, v44, v45
  v_cvt_pk_bf16_f32 v69, v46, v47
  v_mfma_f32_16x16x32_bf16 v[40:43], a[80:83], v[128:131], v[40:43]
  v_cvt_pk_bf16_f32 v70, v48, v49
  v_cvt_pk_bf16_f32 v71, v50, v51
  v_cvt_pk_bf16_f32 v72, v52, v53
  ds_read_b128 v[112:115], v2 offset:46080
  v_mfma_f32_16x16x32_bf16 v[32:35], a[84:87], v[132:135], v[32:35]
  v_cvt_pk_bf16_f32 v73, v54, v55
  s_add_u32 s53, s66, 49152
  s_add_u32 s54, s67, 49152
  v_permlane16_swap_b32 v68, v70
  v_permlane16_swap_b32 v69, v71
  v_mfma_f32_16x16x32_bf16 v[36:39], a[88:91], v[132:135], v[36:39]
  buffer_store_dwordx2 v[72:73], v19, s[8:11], s54 offen sc1
  v_mfma_f32_16x16x32_bf16 v[40:43], a[92:95], v[132:135], v[40:43]
  ds_read_b128 v[116:119], v2 offset:47104
  buffer_load_dwordx4 v[184:187], v6, s[8:11], s51 offen offset:2048 sc1
  s_waitcnt lgkmcnt(4)
  v_mfma_f32_16x16x32_bf16 v[32:35], a[100:103], v[136:139], v[32:35]
  v_mfma_f32_16x16x32_bf16 v[36:39], a[104:107], v[136:139], v[36:39]
  buffer_store_dwordx4 v[68:71], v18, s[8:11], s53 offen sc1
  v_mfma_f32_16x16x32_bf16 v[40:43], a[108:111], v[136:139], v[40:43]
  ds_read_b128 v[120:123], v2 offset:48128
  buffer_load_dwordx4 v[188:191], v6, s[8:11], s51 offen offset:3072 sc1
  v_mfma_f32_16x16x32_bf16 v[32:35], a[112:115], v[140:143], v[32:35]
  v_mfma_f32_16x16x32_bf16 v[36:39], a[116:119], v[140:143], v[36:39]
  v_mfma_f32_16x16x32_bf16 v[40:43], a[120:123], v[140:143], v[40:43]
  ds_read_b128 v[124:127], v2 offset:49152
  s_waitcnt lgkmcnt(4)
  v_mfma_f32_16x16x32_bf16 v[32:35], a[124:127], v[144:147], v[32:35]
  v_mfma_f32_16x16x32_bf16 v[36:39], a[128:131], v[144:147], v[36:39]
  v_mfma_f32_16x16x32_bf16 v[40:43], a[132:135], v[144:147], v[40:43]
  ds_read_b128 v[128:131], v2 offset:50176
  s_mul_i32 s63, s45, 196608
  s_mul_i32 s61, s3, 12288
  s_add_u32 s63, s63, s61
  s_add_u32 s63, s63, 16678912
  s_add_u32 s68, s63, 4096
  s_add_u32 s69, s63, 8192
  s_lshl_b32 s57, s3, 3
  s_lshr_b32 s57, 0xe4b47839, s57
  s_bfe_u32 s55, s57, 0x20000
  s_mul_i32 s56, s55, 49152
  v_add_u32 v108, s56, v2
  s_mul_i32 s74, s55, 15360
  s_sub_u32 s55, s3, s55
  s_sub_u32 s55, s55, 1
  s_and_b32 s55, s55, 3
  s_mul_i32 s55, s55, 5120
  s_add_u32 s74, s74, s55
  s_bfe_u32 s55, s57, 0x20002
  s_mul_i32 s56, s55, 49152
  v_add_u32 v109, s56, v2
  s_mul_i32 s75, s55, 15360
  s_sub_u32 s55, s3, s55
  s_sub_u32 s55, s55, 1
  s_and_b32 s55, s55, 3
  s_mul_i32 s55, s55, 5120
  s_add_u32 s75, s75, s55
  s_bfe_u32 s55, s57, 0x20004
  s_mul_i32 s56, s55, 49152
  v_add_u32 v110, s56, v2
  s_mul_i32 s76, s55, 15360
  s_sub_u32 s55, s3, s55
  s_sub_u32 s55, s55, 1
  s_and_b32 s55, s55, 3
  s_mul_i32 s55, s55, 5120
  s_add_u32 s76, s76, s55
  s_bfe_u32 s55, s57, 0x20006
  s_mul_i32 s56, s55, 49152
  v_add_u32 v111, s56, v2
  s_mul_i32 s77, s55, 15360
  v_mfma_f32_16x16x32_bf16 v[32:35], a[136:139], v[148:151], v[32:35]
  v_mfma_f32_16x16x32_bf16 v[36:39], a[140:143], v[148:151], v[36:39]
  v_mfma_f32_16x16x32_bf16 v[40:43], a[144:147], v[148:151], v[40:43]
  ds_read_b128 v[132:135], v2 offset:51200
  s_waitcnt lgkmcnt(4)
  v_mfma_f32_16x16x32_bf16 v[44:47], a[200:203], v[112:115], 0
  v_mfma_f32_16x16x32_bf16 v[48:51], a[204:207], v[112:115], 0
  v_mfma_f32_16x16x32_bf16 v[52:55], a[208:211], v[112:115], 0
  ds_read_b128 v[136:139], v2 offset:52224
  s_add_u32 s51, s50, 23298048
  buffer_load_dwordx4 a[200:203], v7, s[8:11], s51 offen offset:0 sc1
  s_add_u32 s51, s50, 23339008
  buffer_load_dwordx4 a[204:207], v6, s[8:11], s51 offen offset:0 sc1
  buffer_load_dwordx4 a[208:211], v6, s[8:11], s51 offen offset:1024 sc1
  v_mfma_f32_16x16x32_bf16 v[44:47], a[212:215], v[116:119], v[44:47]
  v_fmac_f32 v32, v20, v103
  v_fmac_f32 v33, v21, v103
  v_fmac_f32 v34, v22, v103
  v_fmac_f32 v35, v23, v103
  v_fmac_f32 v36, v24, v103
  v_mfma_f32_16x16x32_bf16 v[48:51], a[216:219], v[116:119], v[48:51]
  v_fmac_f32 v37, v25, v103
  v_fmac_f32 v38, v26, v103
  v_fmac_f32 v39, v27, v103
  v_fmac_f32 v40, v28, v103
  v_fmac_f32 v41, v29, v103
  v_mfma_f32_16x16x32_bf16 v[52:55], a[220:223], v[116:119], v[52:55]
  ds_read_b128 v[140:143], v2 offset:53248
  s_add_u32 s51, s50, 23339008
  buffer_load_dwordx4 a[212:215], v6, s[8:11], s51 offen offset:2048 sc1
  buffer_load_dwordx4 a[216:219], v6, s[8:11], s51 offen offset:3072 sc1
  buffer_load_dwordx4 a[220:223], v7, s[8:11], s51 offen offset:0 sc1
  s_waitcnt lgkmcnt(4)
  v_mfma_f32_16x16x32_bf16 v[44:47], a[224:227], v[120:123], v[44:47]
  v_mfma_f32_16x16x32_bf16 v[48:51], a[228:231], v[120:123], v[48:51]
  v_mfma_f32_16x16x32_bf16 v[52:55], a[232:235], v[120:123], v[52:55]
  ds_read_b128 v[144:147], v2 offset:54272
  s_add_u32 s51, s50, 23379968
  buffer_load_dwordx4 a[224:227], v6, s[8:11], s51 offen offset:0 sc1
  buffer_load_dwordx4 a[228:231], v6, s[8:11], s51 offen offset:1024 sc1
  buffer_load_dwordx4 a[232:235], v6, s[8:11], s51 offen offset:2048 sc1
  v_mfma_f32_16x16x32_bf16 v[44:47], a[236:239], v[124:127], v[44:47]
  v_mfma_f32_16x16x32_bf16 v[48:51], a[240:243], v[124:127], v[48:51]
  v_mfma_f32_16x16x32_bf16 v[52:55], a[244:247], v[124:127], v[52:55]
  ds_read_b128 v[148:151], v2 offset:55296
  s_add_u32 s51, s50, 23379968
  buffer_load_dwordx4 a[236:239], v6, s[8:11], s51 offen offset:3072 sc1
  buffer_load_dwordx4 a[240:243], v7, s[8:11], s51 offen offset:0 sc1
  s_add_u32 s51, s50, 23420928
  buffer_load_dwordx4 a[244:247], v6, s[8:11], s51 offen offset:0 sc1
  s_waitcnt lgkmcnt(4)
  v_mfma_f32_16x16x32_bf16 v[44:47], a[248:251], v[128:131], v[44:47]
  v_mfma_f32_16x16x32_bf16 v[48:51], a[252:255], v[128:131], v[48:51]
  v_mfma_f32_16x16x32_bf16 v[52:55], v[216:219], v[128:131], v[52:55]
  ds_read_b128 v[112:115], v2 offset:56320
  s_add_u32 s51, s50, 23420928
  buffer_load_dwordx4 a[248:251], v6, s[8:11], s51 offen offset:1024 sc1
  buffer_load_dwordx4 a[252:255], v6, s[8:11], s51 offen offset:2048 sc1
  buffer_load_dwordx4 v[216:219], v6, s[8:11], s51 offen offset:3072 sc1
  v_mfma_f32_16x16x32_bf16 v[44:47], v[220:223], v[132:135], v[44:47]
  v_mfma_f32_16x16x32_bf16 v[48:51], v[224:227], v[132:135], v[48:51]
  v_mfma_f32_16x16x32_bf16 v[52:55], v[228:231], v[132:135], v[52:55]
  ds_read_b128 v[116:119], v2 offset:57344
  s_add_u32 s51, s50, 23420928
  buffer_load_dwordx4 v[220:223], v7, s[8:11], s51 offen offset:0 sc1
  s_waitcnt vmcnt(28)
  ds_read_b128 v[224:227], v8 offset:5120
  ds_read_b128 v[228:231], v8 offset:6144
  s_waitcnt lgkmcnt(6)
  v_mfma_f32_16x16x32_bf16 v[44:47], v[232:235], v[136:139], v[44:47]
  v_mfma_f32_16x16x32_bf16 v[48:51], v[236:239], v[136:139], v[48:51]
  v_mfma_f32_16x16x32_bf16 v[52:55], v[240:243], v[136:139], v[52:55]
  ds_read_b128 v[120:123], v2 offset:58368
  ds_read_b128 v[232:235], v8 offset:7168
  ds_read_b128 v[236:239], v8 offset:8192
  ds_read_b128 v[240:243], v8 offset:9216
  v_mfma_f32_16x16x32_bf16 v[44:47], v[244:247], v[140:143], v[44:47]
  v_fmac_f32 v42, v30, v103
  v_fmac_f32 v43, v31, v103
  v_mfma_f32_16x16x32_bf16 v[48:51], v[248:251], v[140:143], v[48:51]
  v_mul_f32 v56, v32, v32
  v_mul_f32 v57, v33, v33
  v_mul_f32 v58, v34, v34
  v_mul_f32 v59, v35, v35
  v_mul_f32 v60, v36, v36
  v_mfma_f32_16x16x32_bf16 v[52:55], v[252:255], v[140:143], v[52:55]
  ds_read_b128 v[124:127], v2 offset:59392
  ds_read_b128 v[244:247], v8 offset:10240
  ds_read_b128 v[248:251], v8 offset:11264
  ds_read_b128 v[252:255], v8 offset:12288
  s_waitcnt lgkmcnt(12)
  v_mfma_f32_16x16x32_bf16 v[44:47], a[0:3], v[144:147], v[44:47]
  v_mul_f32 v61, v37, v37
  v_mul_f32 v62, v38, v38
  v_mul_f32 v63, v39, v39
  v_mul_f32 v64, v40, v40
  v_mul_f32 v65, v41, v41
  v_mfma_f32_16x16x32_bf16 v[48:51], a[4:7], v[144:147], v[48:51]
  v_mul_f32 v66, v42, v42
  v_mul_f32 v67, v43, v43
  v_fma_f32 v56, v56, v101, v100
  v_fma_f32 v57, v57, v101, v100
  v_fma_f32 v58, v58, v101, v100
  v_fma_f32 v59, v59, v101, v100
  v_mfma_f32_16x16x32_bf16 v[52:55], a[8:11], v[144:147], v[52:55]
  v_fma_f32 v60, v60, v101, v100
  ds_read_b128 v[128:131], v2 offset:60416
  ds_read_b128 a[0:3], v8 offset:13312
  ds_read_b128 a[4:7], v8 offset:14336
  ds_read_b128 a[8:11], v8 offset:15360
  v_mfma_f32_16x16x32_bf16 v[44:47], a[12:15], v[148:151], v[44:47]
  v_fma_f32 v61, v61, v101, v100
  v_fma_f32 v62, v62, v101, v100
  v_fma_f32 v63, v63, v101, v100
  v_fma_f32 v64, v64, v101, v100
  v_fma_f32 v65, v65, v101, v100
  v_mfma_f32_16x16x32_bf16 v[48:51], a[16:19], v[148:151], v[48:51]
  v_fma_f32 v66, v66, v101, v100
  v_fma_f32 v67, v67, v101, v100
  v_mul_f32 v56, v56, v32
  v_mul_f32 v57, v57, v33
  v_mul_f32 v58, v58, v34
  v_mfma_f32_16x16x32_bf16 v[52:55], a[20:23], v[148:151], v[52:55]
  ds_read_b128 v[132:135], v75 offset:51200
  ds_read_b128 a[12:15], v8 offset:16384
  ds_read_b128 a[16:19], v8 offset:17408
  ds_read_b128 a[20:23], v8 offset:18432
  s_waitcnt lgkmcnt(15)
  v_mfma_f32_16x16x32_bf16 v[44:47], a[24:27], v[112:115], v[44:47]
  v_mul_f32 v59, v59, v35
  v_mul_f32 v60, v60, v36
  v_mul_f32 v61, v61, v37
  v_mul_f32 v62, v62, v38
  v_mul_f32 v63, v63, v39
  v_mfma_f32_16x16x32_bf16 v[48:51], a[28:31], v[112:115], v[48:51]
  v_mul_f32 v64, v64, v40
  v_mul_f32 v65, v65, v41
  v_mul_f32 v66, v66, v42
  v_mul_f32 v67, v67, v43
  v_exp_f32 v56, v56
  v_mfma_f32_16x16x32_bf16 v[52:55], a[32:35], v[112:115], v[52:55]
  ds_read_b128 v[136:139], v75 offset:52224
  ds_read_b128 a[24:27], v8 offset:19456
  ds_read_b128 a[28:31], v8 offset:20480
  ds_read_b128 a[32:35], v8 offset:21504
  buffer_load_dwordx4 v[112:115], v108, s[8:11], s63 offen offset:0 sc1
  v_mfma_f32_16x16x32_bf16 v[44:47], a[36:39], v[116:119], v[44:47]
  v_mfma_f32_16x16x32_bf16 v[48:51], a[40:43], v[116:119], v[48:51]
  v_exp_f32 v57, v57
  v_exp_f32 v58, v58
  v_exp_f32 v59, v59
  v_mfma_f32_16x16x32_bf16 v[52:55], a[44:47], v[116:119], v[52:55]
  ds_read_b128 v[140:143], v75 offset:53248
  ds_read_b128 a[36:39], v8 offset:22528
  ds_read_b128 a[40:43], v8 offset:23552
  ds_read_b128 a[44:47], v8 offset:24576
  buffer_load_dwordx4 v[116:119], v108, s[8:11], s63 offen offset:1024 sc1
  s_waitcnt lgkmcnt(15)
  v_mfma_f32_16x16x32_bf16 v[44:47], a[48:51], v[120:123], v[44:47]
  v_mfma_f32_16x16x32_bf16 v[48:51], a[52:55], v[120:123], v[48:51]
  v_exp_f32 v60, v60
  v_exp_f32 v61, v61
  v_exp_f32 v62, v62
  v_mfma_f32_16x16x32_bf16 v[52:55], a[56:59], v[120:123], v[52:55]
  ds_read_b128 v[144:147], v75 offset:54272
  buffer_load_dwordx4 v[120:123], v108, s[8:11], s63 offen offset:2048 sc1
  v_mfma_f32_16x16x32_bf16 v[44:47], a[60:63], v[124:127], v[44:47]
  v_exp_f32 v63, v63
  v_exp_f32 v64, v64
  v_mfma_f32_16x16x32_bf16 v[48:51], a[64:67], v[124:127], v[48:51]
  v_exp_f32 v65, v65
  v_exp_f32 v66, v66
  v_exp_f32 v67, v67
  v_mfma_f32_16x16x32_bf16 v[52:55], a[68:71], v[124:127], v[52:55]
  ds_read_b128 v[148:151], v75 offset:55296
  buffer_load_dwordx4 v[124:127], v108, s[8:11], s63 offen offset:3072 sc1
  s_waitcnt lgkmcnt(13)
  v_mfma_f32_16x16x32_bf16 v[44:47], a[72:75], v[128:131], v[44:47]
  v_fma_f32 v56, v56, v102, v102
  v_fma_f32 v57, v57, v102, v102
  v_mfma_f32_16x16x32_bf16 v[48:51], a[76:79], v[128:131], v[48:51]
  v_fma_f32 v58, v58, v102, v102
  v_fma_f32 v59, v59, v102, v102
  v_fma_f32 v60, v60, v102, v102
  v_fma_f32 v61, v61, v102, v102
  v_fma_f32 v62, v62, v102, v102
  v_mfma_f32_16x16x32_bf16 v[52:55], a[80:83], v[128:131], v[52:55]
  v_fma_f32 v63, v63, v102, v102
  buffer_load_dwordx4 v[128:131], v108, s[8:11], s68 offen offset:0 sc1
  v_mfma_f32_16x16x32_bf16 v[44:47], a[84:87], v[132:135], v[44:47]
  v_fma_f32 v64, v64, v102, v102
  v_fma_f32 v65, v65, v102, v102
  v_fma_f32 v66, v66, v102, v102
  v_fma_f32 v67, v67, v102, v102
  v_mfma_f32_16x16x32_bf16 v[48:51], a[88:91], v[132:135], v[48:51]
  v_rcp_f32 v56, v56
  v_rcp_f32 v57, v57
  v_rcp_f32 v58, v58
  v_mfma_f32_16x16x32_bf16 v[52:55], a[92:95], v[132:135], v[52:55]
  buffer_load_dwordx4 v[132:135], v108, s[8:11], s68 offen offset:1024 sc1
  s_waitcnt lgkmcnt(5)
  v_mfma_f32_16x16x32_bf16 v[44:47], a[100:103], v[136:139], v[44:47]
  v_rcp_f32 v59, v59
  v_rcp_f32 v60, v60
  v_mfma_f32_16x16x32_bf16 v[48:51], a[104:107], v[136:139], v[48:51]
  v_rcp_f32 v61, v61
  v_rcp_f32 v62, v62
  v_rcp_f32 v63, v63
  v_mfma_f32_16x16x32_bf16 v[52:55], a[108:111], v[136:139], v[52:55]
  buffer_load_dwordx4 v[136:139], v108, s[8:11], s68 offen offset:2048 sc1
  v_mfma_f32_16x16x32_bf16 v[44:47], a[112:115], v[140:143], v[44:47]
  v_rcp_f32 v64, v64
  v_rcp_f32 v65, v65
  v_mfma_f32_16x16x32_bf16 v[48:51], a[116:119], v[140:143], v[48:51]
  v_rcp_f32 v66, v66
  v_rcp_f32 v67, v67
  v_mul_f32 v32, v32, v56
  v_mul_f32 v33, v33, v57
  v_mfma_f32_16x16x32_bf16 v[52:55], a[120:123], v[140:143], v[52:55]
  buffer_load_dwordx4 v[140:143], v108, s[8:11], s68 offen offset:3072 sc1
  s_waitcnt lgkmcnt(0)
  v_mfma_f32_16x16x32_bf16 v[44:47], a[124:127], v[144:147], v[44:47]
  v_mul_f32 v34, v34, v58
  v_mul_f32 v35, v35, v59
  v_mul_f32 v36, v36, v60
  v_mul_f32 v37, v37, v61
  v_mfma_f32_16x16x32_bf16 v[48:51], a[128:131], v[144:147], v[48:51]
  v_mul_f32 v38, v38, v62
  v_mul_f32 v39, v39, v63
  v_mul_f32 v40, v40, v64
  v_mul_f32 v41, v41, v65
  v_mul_f32 v42, v42, v66
  v_mfma_f32_16x16x32_bf16 v[52:55], a[132:135], v[144:147], v[52:55]
  v_mul_f32 v43, v43, v67
  v_cvt_pk_bf16_f32 v68, v32, v33
  v_cvt_pk_bf16_f32 v69, v34, v35
  v_cvt_pk_bf16_f32 v70, v36, v37
  v_cvt_pk_bf16_f32 v71, v38, v39
  v_cvt_pk_bf16_f32 v72, v40, v41
  v_mfma_f32_16x16x32_bf16 v[44:47], a[136:139], v[148:151], v[44:47]
  v_cvt_pk_bf16_f32 v73, v42, v43
  s_add_u32 s53, s66, 98304
  s_add_u32 s54, s67, 98304
  v_permlane16_swap_b32 v68, v70
  v_permlane16_swap_b32 v69, v71
  v_mfma_f32_16x16x32_bf16 v[48:51], a[140:143], v[148:151], v[48:51]
  buffer_store_dwordx2 v[72:73], v19, s[8:11], s54 offen sc1
  v_mfma_f32_16x16x32_bf16 v[52:55], a[144:147], v[148:151], v[52:55]
  buffer_store_dwordx4 v[68:71], v18, s[8:11], s53 offen sc1
  v_pk_fma_f32 v[44:45], v[20:21], v[106:107], v[44:45] op_sel:[0,1,0] op_sel_hi:[1,1,1]
  v_pk_fma_f32 v[46:47], v[22:23], v[106:107], v[46:47] op_sel:[0,1,0] op_sel_hi:[1,1,1]
  s_nop 2
  v_pk_fma_f32 v[48:49], v[24:25], v[106:107], v[48:49] op_sel:[0,1,0] op_sel_hi:[1,1,1]
  v_pk_fma_f32 v[50:51], v[26:27], v[106:107], v[50:51] op_sel:[0,1,0] op_sel_hi:[1,1,1]
  v_pk_fma_f32 v[52:53], v[28:29], v[106:107], v[52:53] op_sel:[0,1,0] op_sel_hi:[1,1,1]
  v_pk_fma_f32 v[54:55], v[30:31], v[106:107], v[54:55] op_sel:[0,1,0] op_sel_hi:[1,1,1]
  v_pk_mul_f32 v[56:57], v[44:45], v[44:45]
  v_pk_mul_f32 v[58:59], v[46:47], v[46:47]
  v_pk_mul_f32 v[60:61], v[48:49], v[48:49]
  v_pk_mul_f32 v[62:63], v[50:51], v[50:51]
  v_pk_mul_f32 v[64:65], v[52:53], v[52:53]
  v_pk_mul_f32 v[66:67], v[54:55], v[54:55]
  v_pk_fma_f32 v[56:57], v[56:57], v[104:105], v[104:105] op_sel:[0,1,0] op_sel_hi:[1,1,0]
  v_pk_fma_f32 v[58:59], v[58:59], v[104:105], v[104:105] op_sel:[0,1,0] op_sel_hi:[1,1,0]
  v_pk_fma_f32 v[60:61], v[60:61], v[104:105], v[104:105] op_sel:[0,1,0] op_sel_hi:[1,1,0]
  v_pk_fma_f32 v[62:63], v[62:63], v[104:105], v[104:105] op_sel:[0,1,0] op_sel_hi:[1,1,0]
  v_pk_fma_f32 v[64:65], v[64:65], v[104:105], v[104:105] op_sel:[0,1,0] op_sel_hi:[1,1,0]
  v_pk_fma_f32 v[66:67], v[66:67], v[104:105], v[104:105] op_sel:[0,1,0] op_sel_hi:[1,1,0]
  v_pk_mul_f32 v[56:57], v[56:57], v[44:45]
  v_pk_mul_f32 v[58:59], v[58:59], v[46:47]
  v_pk_mul_f32 v[60:61], v[60:61], v[48:49]
  v_pk_mul_f32 v[62:63], v[62:63], v[50:51]
  v_pk_mul_f32 v[64:65], v[64:65], v[52:53]
  v_pk_mul_f32 v[66:67], v[66:67], v[54:55]
  v_exp_f32 v56, v56
  v_exp_f32 v57, v57
  v_exp_f32 v58, v58
  v_exp_f32 v59, v59
  v_exp_f32 v60, v60
  v_exp_f32 v61, v61
  v_exp_f32 v62, v62
  v_exp_f32 v63, v63
  v_exp_f32 v64, v64
  v_exp_f32 v65, v65
  v_exp_f32 v66, v66
  v_exp_f32 v67, v67
  v_pk_fma_f32 v[56:57], v[56:57], v[106:107], v[106:107] op_sel_hi:[1,0,0]
  v_pk_fma_f32 v[58:59], v[58:59], v[106:107], v[106:107] op_sel_hi:[1,0,0]
  v_pk_fma_f32 v[60:61], v[60:61], v[106:107], v[106:107] op_sel_hi:[1,0,0]
  v_pk_fma_f32 v[62:63], v[62:63], v[106:107], v[106:107] op_sel_hi:[1,0,0]
  v_pk_fma_f32 v[64:65], v[64:65], v[106:107], v[106:107] op_sel_hi:[1,0,0]
  v_pk_fma_f32 v[66:67], v[66:67], v[106:107], v[106:107] op_sel_hi:[1,0,0]
  v_rcp_f32 v56, v56
  v_rcp_f32 v57, v57
  v_rcp_f32 v58, v58
  v_rcp_f32 v59, v59
  v_rcp_f32 v60, v60
  v_rcp_f32 v61, v61
  v_rcp_f32 v62, v62
  v_rcp_f32 v63, v63
  v_rcp_f32 v64, v64
  v_rcp_f32 v65, v65
  v_rcp_f32 v66, v66
  v_rcp_f32 v67, v67
  v_pk_mul_f32 v[44:45], v[44:45], v[56:57]
  v_pk_mul_f32 v[46:47], v[46:47], v[58:59]
  v_pk_mul_f32 v[48:49], v[48:49], v[60:61]
  v_pk_mul_f32 v[50:51], v[50:51], v[62:63]
  v_pk_mul_f32 v[52:53], v[52:53], v[64:65]
  v_pk_mul_f32 v[54:55], v[54:55], v[66:67]
  v_cvt_pk_bf16_f32 v68, v44, v45
  v_cvt_pk_bf16_f32 v69, v46, v47
  v_cvt_pk_bf16_f32 v70, v48, v49
  v_cvt_pk_bf16_f32 v71, v50, v51
  v_cvt_pk_bf16_f32 v72, v52, v53
  v_cvt_pk_bf16_f32 v73, v54, v55
  s_add_u32 s53, s66, 147456
  s_add_u32 s54, s67, 147456
  v_permlane16_swap_b32 v68, v70
  v_permlane16_swap_b32 v69, v71
  buffer_store_dwordx2 v[72:73], v19, s[8:11], s54 offen sc1
  buffer_store_dwordx4 v[68:71], v18, s[8:11], s53 offen sc1
  s_waitcnt lgkmcnt(0)
  s_barrier
  s_waitcnt vmcnt(8)
  v_max3_u32 v0, v112, v115, 0
  v_max3_u32 v0, v116, v119, v0
  v_max3_u32 v0, v120, v123, v0
  v_max3_u32 v0, v124, v127, v0
  v_cmp_eq_u32 vcc, -1, v0
  s_cbranch_vccnz Lretry25
Lresume26:
  buffer_load_dwordx4 v[144:147], v108, s[8:11], s69 offen offset:0 sc1
  buffer_load_dwordx4 v[148:151], v108, s[8:11], s69 offen offset:1024 sc1
  buffer_load_dwordx4 v[72:75], v108, s[8:11], s69 offen offset:2048 sc1
  buffer_load_dwordx4 v[76:79], v108, s[8:11], s69 offen offset:3072 sc1
  v_mfma_f32_16x16x32_bf16 v[32:35], a[148:151], v[112:115], 0
  v_mfma_f32_16x16x32_bf16 v[36:39], a[152:155], v[112:115], 0
  v_mfma_f32_16x16x32_bf16 v[40:43], a[156:159], v[112:115], 0
  buffer_load_dwordx4 v[80:83], v109, s[8:11], s63 offen offset:0 sc1
  v_mfma_f32_16x16x32_bf16 v[44:47], a[160:163], v[112:115], 0
  v_mfma_f32_16x16x32_bf16 v[48:51], a[164:167], v[112:115], 0
  v_mfma_f32_16x16x32_bf16 v[32:35], a[168:171], v[116:119], v[32:35]
  v_mfma_f32_16x16x32_bf16 v[36:39], a[172:175], v[116:119], v[36:39]
  buffer_load_dwordx4 v[84:87], v109, s[8:11], s63 offen offset:1024 sc1
  v_mfma_f32_16x16x32_bf16 v[40:43], a[176:179], v[116:119], v[40:43]
  v_mfma_f32_16x16x32_bf16 v[44:47], a[180:183], v[116:119], v[44:47]
  v_mfma_f32_16x16x32_bf16 v[48:51], a[184:187], v[116:119], v[48:51]
  v_mfma_f32_16x16x32_bf16 v[32:35], a[188:191], v[120:123], v[32:35]
  buffer_load_dwordx4 v[88:91], v109, s[8:11], s63 offen offset:2048 sc1
  v_mfma_f32_16x16x32_bf16 v[36:39], a[192:195], v[120:123], v[36:39]
  v_mfma_f32_16x16x32_bf16 v[40:43], a[196:199], v[120:123], v[40:43]
  v_mfma_f32_16x16x32_bf16 v[44:47], a[96:99], v[120:123], v[44:47]
  buffer_load_dwordx4 v[92:95], v109, s[8:11], s63 offen offset:3072 sc1
  v_mfma_f32_16x16x32_bf16 v[48:51], v[152:155], v[120:123], v[48:51]
  v_mfma_f32_16x16x32_bf16 v[32:35], v[156:159], v[124:127], v[32:35]
  s_waitcnt vmcnt(12)
  v_mfma_f32_16x16x32_bf16 v[36:39], v[160:163], v[124:127], v[36:39]
  v_max3_u32 v0, v128, v131, 0
  v_max3_u32 v0, v132, v135, v0
  v_mfma_f32_16x16x32_bf16 v[40:43], v[164:167], v[124:127], v[40:43]
  v_max3_u32 v0, v136, v139, v0
  v_mfma_f32_16x16x32_bf16 v[44:47], v[168:171], v[124:127], v[44:47]
  v_max3_u32 v0, v140, v143, v0
  v_cmp_eq_u32 vcc, -1, v0
  v_mfma_f32_16x16x32_bf16 v[48:51], v[172:175], v[124:127], v[48:51]
  s_cbranch_vccnz Lretry27
Lresume28:
  v_mfma_f32_16x16x32_bf16 v[32:35], v[176:179], v[128:131], v[32:35]
  v_mfma_f32_16x16x32_bf16 v[36:39], v[180:183], v[128:131], v[36:39]
  buffer_load_dwordx4 v[112:115], v109, s[8:11], s68 offen offset:0 sc1
  v_mfma_f32_16x16x32_bf16 v[40:43], v[184:187], v[128:131], v[40:43]
  v_mfma_f32_16x16x32_bf16 v[44:47], v[188:191], v[128:131], v[44:47]
  v_mfma_f32_16x16x32_bf16 v[48:51], v[224:227], v[128:131], v[48:51]
  v_mfma_f32_16x16x32_bf16 v[32:35], v[228:231], v[132:135], v[32:35]
  buffer_load_dwordx4 v[116:119], v109, s[8:11], s68 offen offset:1024 sc1
  v_mfma_f32_16x16x32_bf16 v[36:39], v[232:235], v[132:135], v[36:39]
  v_mfma_f32_16x16x32_bf16 v[40:43], v[236:239], v[132:135], v[40:43]
  v_mfma_f32_16x16x32_bf16 v[44:47], v[240:243], v[132:135], v[44:47]
  v_mfma_f32_16x16x32_bf16 v[48:51], v[244:247], v[132:135], v[48:51]
  buffer_load_dwordx4 v[120:123], v109, s[8:11], s68 offen offset:2048 sc1
  v_mfma_f32_16x16x32_bf16 v[32:35], v[248:251], v[136:139], v[32:35]
  v_mfma_f32_16x16x32_bf16 v[36:39], v[252:255], v[136:139], v[36:39]
  v_mfma_f32_16x16x32_bf16 v[40:43], a[0:3], v[136:139], v[40:43]
  buffer_load_dwordx4 v[124:127], v109, s[8:11], s68 offen offset:3072 sc1
  v_mfma_f32_16x16x32_bf16 v[44:47], a[4:7], v[136:139], v[44:47]
  v_mfma_f32_16x16x32_bf16 v[48:51], a[8:11], v[136:139], v[48:51]
  v_mfma_f32_16x16x32_bf16 v[32:35], a[12:15], v[140:143], v[32:35]
  s_waitcnt vmcnt(8)
  v_max3_u32 v0, v144, v147, 0
  v_mfma_f32_16x16x32_bf16 v[36:39], a[16:19], v[140:143], v[36:39]
  v_max3_u32 v0, v148, v151, v0
  v_mfma_f32_16x16x32_bf16 v[40:43], a[20:23], v[140:143], v[40:43]
  v_max3_u32 v0, v72, v75, v0
  v_mfma_f32_16x16x32_bf16 v[44:47], a[24:27], v[140:143], v[44:47]
  v_max3_u32 v0, v76, v79, v0
  v_cmp_eq_u32 vcc, -1, v0
  v_mfma_f32_16x16x32_bf16 v[48:51], a[28:31], v[140:143], v[48:51]
  s_cbranch_vccnz Lretry29
Lresume30:
  v_mfma_f32_16x16x32_bf16 v[32:35], a[32:35], v[144:147], v[32:35]
  v_mfma_f32_16x16x32_bf16 v[36:39], a[36:39], v[144:147], v[36:39]
  buffer_load_dwordx4 v[128:131], v109, s[8:11], s69 offen offset:0 sc1
  v_mfma_f32_16x16x32_bf16 v[40:43], a[40:43], v[144:147], v[40:43]
  v_mfma_f32_16x16x32_bf16 v[44:47], a[44:47], v[144:147], v[44:47]
  v_mfma_f32_16x16x32_bf16 v[48:51], a[200:203], v[144:147], v[48:51]
  v_mfma_f32_16x16x32_bf16 v[32:35], a[204:207], v[148:151], v[32:35]
  buffer_load_dwordx4 v[132:135], v109, s[8:11], s69 offen offset:1024 sc1
  v_mfma_f32_16x16x32_bf16 v[36:39], a[208:211], v[148:151], v[36:39]
  v_mfma_f32_16x16x32_bf16 v[40:43], a[212:215], v[148:151], v[40:43]
  v_mfma_f32_16x16x32_bf16 v[44:47], a[216:219], v[148:151], v[44:47]
  v_mfma_f32_16x16x32_bf16 v[48:51], a[220:223], v[148:151], v[48:51]
  buffer_load_dwordx4 v[136:139], v109, s[8:11], s69 offen offset:2048 sc1
  v_mfma_f32_16x16x32_bf16 v[32:35], a[224:227], v[72:75], v[32:35]
  v_mfma_f32_16x16x32_bf16 v[36:39], a[228:231], v[72:75], v[36:39]
  v_mfma_f32_16x16x32_bf16 v[40:43], a[232:235], v[72:75], v[40:43]
  buffer_load_dwordx4 v[140:143], v109, s[8:11], s69 offen offset:3072 sc1
  v_mfma_f32_16x16x32_bf16 v[44:47], a[236:239], v[72:75], v[44:47]
  v_mfma_f32_16x16x32_bf16 v[48:51], a[240:243], v[72:75], v[48:51]
  v_mfma_f32_16x16x32_bf16 v[32:35], a[244:247], v[76:79], v[32:35]
  s_waitcnt vmcnt(8)
  v_max3_u32 v0, v80, v83, 0
  v_mfma_f32_16x16x32_bf16 v[36:39], a[248:251], v[76:79], v[36:39]
  v_max3_u32 v0, v84, v87, v0
  v_mfma_f32_16x16x32_bf16 v[40:43], a[252:255], v[76:79], v[40:43]
  v_max3_u32 v0, v88, v91, v0
  v_mfma_f32_16x16x32_bf16 v[44:47], v[216:219], v[76:79], v[44:47]
  v_max3_u32 v0, v92, v95, v0
  v_cmp_eq_u32 vcc, -1, v0
  v_mfma_f32_16x16x32_bf16 v[48:51], v[220:223], v[76:79], v[48:51]
  s_cbranch_vccnz Lretry31
Lresume32:
  v_mfma_f32_16x16x32_bf16 v[52:55], a[148:151], v[80:83], 0
  v_mfma_f32_16x16x32_bf16 v[56:59], a[152:155], v[80:83], 0
  v_mfma_f32_16x16x32_bf16 v[60:63], a[156:159], v[80:83], 0
  buffer_load_dwordx4 v[144:147], v110, s[8:11], s63 offen offset:0 sc1
  v_mfma_f32_16x16x32_bf16 v[64:67], a[160:163], v[80:83], 0
  v_mfma_f32_16x16x32_bf16 v[68:71], a[164:167], v[80:83], 0
  v_mfma_f32_16x16x32_bf16 v[52:55], a[168:171], v[84:87], v[52:55]
  v_add_u32 v16, s74, v2
  ds_write_b128 v16, v[32:35] offset:0
  v_mfma_f32_16x16x32_bf16 v[56:59], a[172:175], v[84:87], v[56:59]
  ds_write_b128 v16, v[36:39] offset:1024
  ds_write_b128 v16, v[40:43] offset:2048
  v_mfma_f32_16x16x32_bf16 v[60:63], a[176:179], v[84:87], v[60:63]
  v_mfma_f32_16x16x32_bf16 v[64:67], a[180:183], v[84:87], v[64:67]
  buffer_load_dwordx4 v[148:151], v110, s[8:11], s63 offen offset:1024 sc1
  v_mfma_f32_16x16x32_bf16 v[68:71], a[184:187], v[84:87], v[68:71]
  v_mfma_f32_16x16x32_bf16 v[52:55], a[188:191], v[88:91], v[52:55]
  ds_write_b128 v16, v[44:47] offset:3072
  ds_write_b128 v16, v[48:51] offset:4096
  v_mfma_f32_16x16x32_bf16 v[56:59], a[192:195], v[88:91], v[56:59]
  v_mfma_f32_16x16x32_bf16 v[60:63], a[196:199], v[88:91], v[60:63]
  buffer_load_dwordx4 v[72:75], v110, s[8:11], s63 offen offset:2048 sc1
  v_mfma_f32_16x16x32_bf16 v[64:67], a[96:99], v[88:91], v[64:67]
  v_mfma_f32_16x16x32_bf16 v[68:71], v[152:155], v[88:91], v[68:71]
  buffer_load_dwordx4 v[76:79], v110, s[8:11], s63 offen offset:3072 sc1
  v_mfma_f32_16x16x32_bf16 v[52:55], v[156:159], v[92:95], v[52:55]
  v_mfma_f32_16x16x32_bf16 v[56:59], v[160:163], v[92:95], v[56:59]
  s_waitcnt vmcnt(8)
  v_mfma_f32_16x16x32_bf16 v[60:63], v[164:167], v[92:95], v[60:63]
  v_max3_u32 v0, v112, v115, 0
  v_max3_u32 v0, v116, v119, v0
  v_mfma_f32_16x16x32_bf16 v[64:67], v[168:171], v[92:95], v[64:67]
  v_max3_u32 v0, v120, v123, v0
  v_max3_u32 v0, v124, v127, v0
  v_mfma_f32_16x16x32_bf16 v[68:71], v[172:175], v[92:95], v[68:71]
  v_cmp_eq_u32 vcc, -1, v0
  s_cbranch_vccnz Lretry33
Lresume34:
  v_mfma_f32_16x16x32_bf16 v[52:55], v[176:179], v[112:115], v[52:55]
  v_mfma_f32_16x16x32_bf16 v[56:59], v[180:183], v[112:115], v[56:59]
  buffer_load_dwordx4 v[80:83], v110, s[8:11], s68 offen offset:0 sc1
  v_mfma_f32_16x16x32_bf16 v[60:63], v[184:187], v[112:115], v[60:63]
  v_mfma_f32_16x16x32_bf16 v[64:67], v[188:191], v[112:115], v[64:67]
  v_mfma_f32_16x16x32_bf16 v[68:71], v[224:227], v[112:115], v[68:71]
  v_mfma_f32_16x16x32_bf16 v[52:55], v[228:231], v[116:119], v[52:55]
  buffer_load_dwordx4 v[84:87], v110, s[8:11], s68 offen offset:1024 sc1
  v_mfma_f32_16x16x32_bf16 v[56:59], v[232:235], v[116:119], v[56:59]
  v_mfma_f32_16x16x32_bf16 v[60:63], v[236:239], v[116:119], v[60:63]
  v_mfma_f32_16x16x32_bf16 v[64:67], v[240:243], v[116:119], v[64:67]
  v_mfma_f32_16x16x32_bf16 v[68:71], v[244:247], v[116:119], v[68:71]
  buffer_load_dwordx4 v[88:91], v110, s[8:11], s68 offen offset:2048 sc1
  v_mfma_f32_16x16x32_bf16 v[52:55], v[248:251], v[120:123], v[52:55]
  v_mfma_f32_16x16x32_bf16 v[56:59], v[252:255], v[120:123], v[56:59]
  v_mfma_f32_16x16x32_bf16 v[60:63], a[0:3], v[120:123], v[60:63]
  buffer_load_dwordx4 v[92:95], v110, s[8:11], s68 offen offset:3072 sc1
  v_mfma_f32_16x16x32_bf16 v[64:67], a[4:7], v[120:123], v[64:67]
  v_mfma_f32_16x16x32_bf16 v[68:71], a[8:11], v[120:123], v[68:71]
  v_mfma_f32_16x16x32_bf16 v[52:55], a[12:15], v[124:127], v[52:55]
  s_waitcnt vmcnt(8)
  v_max3_u32 v0, v128, v131, 0
  v_mfma_f32_16x16x32_bf16 v[56:59], a[16:19], v[124:127], v[56:59]
  v_max3_u32 v0, v132, v135, v0
  v_mfma_f32_16x16x32_bf16 v[60:63], a[20:23], v[124:127], v[60:63]
  v_max3_u32 v0, v136, v139, v0
  v_mfma_f32_16x16x32_bf16 v[64:67], a[24:27], v[124:127], v[64:67]
  v_max3_u32 v0, v140, v143, v0
  v_cmp_eq_u32 vcc, -1, v0
  v_mfma_f32_16x16x32_bf16 v[68:71], a[28:31], v[124:127], v[68:71]
  s_cbranch_vccnz Lretry35
Lresume36:
  v_mfma_f32_16x16x32_bf16 v[52:55], a[32:35], v[128:131], v[52:55]
  v_mfma_f32_16x16x32_bf16 v[56:59], a[36:39], v[128:131], v[56:59]
  buffer_load_dwordx4 v[112:115], v110, s[8:11], s69 offen offset:0 sc1
  v_mfma_f32_16x16x32_bf16 v[60:63], a[40:43], v[128:131], v[60:63]
  v_mfma_f32_16x16x32_bf16 v[64:67], a[44:47], v[128:131], v[64:67]
  v_mfma_f32_16x16x32_bf16 v[68:71], a[200:203], v[128:131], v[68:71]
  v_mfma_f32_16x16x32_bf16 v[52:55], a[204:207], v[132:135], v[52:55]
  buffer_load_dwordx4 v[116:119], v110, s[8:11], s69 offen offset:1024 sc1
  v_mfma_f32_16x16x32_bf16 v[56:59], a[208:211], v[132:135], v[56:59]
  v_mfma_f32_16x16x32_bf16 v[60:63], a[212:215], v[132:135], v[60:63]
  v_mfma_f32_16x16x32_bf16 v[64:67], a[216:219], v[132:135], v[64:67]
  v_mfma_f32_16x16x32_bf16 v[68:71], a[220:223], v[132:135], v[68:71]
  buffer_load_dwordx4 v[120:123], v110, s[8:11], s69 offen offset:2048 sc1
  v_mfma_f32_16x16x32_bf16 v[52:55], a[224:227], v[136:139], v[52:55]
  v_mfma_f32_16x16x32_bf16 v[56:59], a[228:231], v[136:139], v[56:59]
  v_mfma_f32_16x16x32_bf16 v[60:63], a[232:235], v[136:139], v[60:63]
  buffer_load_dwordx4 v[124:127], v110, s[8:11], s69 offen offset:3072 sc1
  v_mfma_f32_16x16x32_bf16 v[64:67], a[236:239], v[136:139], v[64:67]
  v_mfma_f32_16x16x32_bf16 v[68:71], a[240:243], v[136:139], v[68:71]
  v_mfma_f32_16x16x32_bf16 v[52:55], a[244:247], v[140:143], v[52:55]
  s_waitcnt vmcnt(8)
  v_max3_u32 v0, v144, v147, 0
  v_mfma_f32_16x16x32_bf16 v[56:59], a[248:251], v[140:143], v[56:59]
  v_max3_u32 v0, v148, v151, v0
  v_mfma_f32_16x16x32_bf16 v[60:63], a[252:255], v[140:143], v[60:63]
  v_max3_u32 v0, v72, v75, v0
  v_mfma_f32_16x16x32_bf16 v[64:67], v[216:219], v[140:143], v[64:67]
  v_max3_u32 v0, v76, v79, v0
  v_cmp_eq_u32 vcc, -1, v0
  v_mfma_f32_16x16x32_bf16 v[68:71], v[220:223], v[140:143], v[68:71]
  s_cbranch_vccnz Lretry37
Lresume38:
  v_mfma_f32_16x16x32_bf16 v[32:35], a[148:151], v[144:147], 0
  v_mfma_f32_16x16x32_bf16 v[36:39], a[152:155], v[144:147], 0
  v_mfma_f32_16x16x32_bf16 v[40:43], a[156:159], v[144:147], 0
  buffer_load_dwordx4 v[128:131], v111, s[8:11], s63 offen offset:0 sc1
  v_mfma_f32_16x16x32_bf16 v[44:47], a[160:163], v[144:147], 0
  v_mfma_f32_16x16x32_bf16 v[48:51], a[164:167], v[144:147], 0
  v_mfma_f32_16x16x32_bf16 v[32:35], a[168:171], v[148:151], v[32:35]
  v_add_u32 v16, s75, v2
  ds_write_b128 v16, v[52:55] offset:0
  v_mfma_f32_16x16x32_bf16 v[36:39], a[172:175], v[148:151], v[36:39]
  ds_write_b128 v16, v[56:59] offset:1024
  ds_write_b128 v16, v[60:63] offset:2048
  v_mfma_f32_16x16x32_bf16 v[40:43], a[176:179], v[148:151], v[40:43]
  v_mfma_f32_16x16x32_bf16 v[44:47], a[180:183], v[148:151], v[44:47]
  buffer_load_dwordx4 v[132:135], v111, s[8:11], s63 offen offset:1024 sc1
  v_mfma_f32_16x16x32_bf16 v[48:51], a[184:187], v[148:151], v[48:51]
  v_mfma_f32_16x16x32_bf16 v[32:35], a[188:191], v[72:75], v[32:35]
  ds_write_b128 v16, v[64:67] offset:3072
  ds_write_b128 v16, v[68:71] offset:4096
  v_mfma_f32_16x16x32_bf16 v[36:39], a[192:195], v[72:75], v[36:39]
  v_mfma_f32_16x16x32_bf16 v[40:43], a[196:199], v[72:75], v[40:43]
  buffer_load_dwordx4 v[136:139], v111, s[8:11], s63 offen offset:2048 sc1
  v_mfma_f32_16x16x32_bf16 v[44:47], a[96:99], v[72:75], v[44:47]
  v_mfma_f32_16x16x32_bf16 v[48:51], v[152:155], v[72:75], v[48:51]
  buffer_load_dwordx4 v[140:143], v111, s[8:11], s63 offen offset:3072 sc1
  v_mfma_f32_16x16x32_bf16 v[32:35], v[156:159], v[76:79], v[32:35]
  v_mfma_f32_16x16x32_bf16 v[36:39], v[160:163], v[76:79], v[36:39]
  s_waitcnt vmcnt(8)
  v_mfma_f32_16x16x32_bf16 v[40:43], v[164:167], v[76:79], v[40:43]
  v_max3_u32 v0, v80, v83, 0
  v_max3_u32 v0, v84, v87, v0
  v_mfma_f32_16x16x32_bf16 v[44:47], v[168:171], v[76:79], v[44:47]
  v_max3_u32 v0, v88, v91, v0
  v_max3_u32 v0, v92, v95, v0
  v_mfma_f32_16x16x32_bf16 v[48:51], v[172:175], v[76:79], v[48:51]
  v_cmp_eq_u32 vcc, -1, v0
  s_cbranch_vccnz Lretry39
Lresume40:
  v_mfma_f32_16x16x32_bf16 v[32:35], v[176:179], v[80:83], v[32:35]
  v_mfma_f32_16x16x32_bf16 v[36:39], v[180:183], v[80:83], v[36:39]
  buffer_load_dwordx4 v[144:147], v111, s[8:11], s68 offen offset:0 sc1
  v_mfma_f32_16x16x32_bf16 v[40:43], v[184:187], v[80:83], v[40:43]
  v_mfma_f32_16x16x32_bf16 v[44:47], v[188:191], v[80:83], v[44:47]
  v_mfma_f32_16x16x32_bf16 v[48:51], v[224:227], v[80:83], v[48:51]
  v_mfma_f32_16x16x32_bf16 v[32:35], v[228:231], v[84:87], v[32:35]
  buffer_load_dwordx4 v[148:151], v111, s[8:11], s68 offen offset:1024 sc1
  v_mfma_f32_16x16x32_bf16 v[36:39], v[232:235], v[84:87], v[36:39]
  v_mfma_f32_16x16x32_bf16 v[40:43], v[236:239], v[84:87], v[40:43]
  v_mfma_f32_16x16x32_bf16 v[44:47], v[240:243], v[84:87], v[44:47]
  v_mfma_f32_16x16x32_bf16 v[48:51], v[244:247], v[84:87], v[48:51]
  buffer_load_dwordx4 v[72:75], v111, s[8:11], s68 offen offset:2048 sc1
  v_mfma_f32_16x16x32_bf16 v[32:35], v[248:251], v[88:91], v[32:35]
  v_mfma_f32_16x16x32_bf16 v[36:39], v[252:255], v[88:91], v[36:39]
  v_mfma_f32_16x16x32_bf16 v[40:43], a[0:3], v[88:91], v[40:43]
  buffer_load_dwordx4 v[76:79], v111, s[8:11], s68 offen offset:3072 sc1
  v_mfma_f32_16x16x32_bf16 v[44:47], a[4:7], v[88:91], v[44:47]
  v_mfma_f32_16x16x32_bf16 v[48:51], a[8:11], v[88:91], v[48:51]
  v_mfma_f32_16x16x32_bf16 v[32:35], a[12:15], v[92:95], v[32:35]
  s_waitcnt vmcnt(8)
  v_max3_u32 v0, v112, v115, 0
  v_mfma_f32_16x16x32_bf16 v[36:39], a[16:19], v[92:95], v[36:39]
  v_max3_u32 v0, v116, v119, v0
  v_mfma_f32_16x16x32_bf16 v[40:43], a[20:23], v[92:95], v[40:43]
  v_max3_u32 v0, v120, v123, v0
  v_mfma_f32_16x16x32_bf16 v[44:47], a[24:27], v[92:95], v[44:47]
  v_max3_u32 v0, v124, v127, v0
  v_cmp_eq_u32 vcc, -1, v0
  v_mfma_f32_16x16x32_bf16 v[48:51], a[28:31], v[92:95], v[48:51]
  s_cbranch_vccnz Lretry41
Lresume42:
  v_mfma_f32_16x16x32_bf16 v[32:35], a[32:35], v[112:115], v[32:35]
  buffer_load_dwordx4 v[80:83], v111, s[8:11], s69 offen offset:0 sc1
  v_mfma_f32_16x16x32_bf16 v[36:39], a[36:39], v[112:115], v[36:39]
  v_mfma_f32_16x16x32_bf16 v[40:43], a[40:43], v[112:115], v[40:43]
  buffer_load_dwordx4 v[84:87], v111, s[8:11], s69 offen offset:1024 sc1
  v_mfma_f32_16x16x32_bf16 v[44:47], a[44:47], v[112:115], v[44:47]
  v_mfma_f32_16x16x32_bf16 v[48:51], a[200:203], v[112:115], v[48:51]
  s_mov_b32 s65, s46
  s_and_b32 s53, s65, 1
  s_mul_i32 s54, s65, 80
  v_mfma_f32_16x16x32_bf16 v[32:35], a[204:207], v[116:119], v[32:35]
  s_lshl_b32 s66, s53, 4
  s_add_u32 s66, s66, s54
  v_mfma_f32_16x16x32_bf16 v[36:39], a[208:211], v[116:119], v[36:39]
  s_xor_b32 s53, s53, 1
  s_mul_i32 s67, s53, 64
  s_add_u32 s67, s67, s54
  v_mfma_f32_16x16x32_bf16 v[40:43], a[212:215], v[116:119], v[40:43]
  s_lshl_b32 s64, s45, 2
  s_add_u32 s64, s64, s3
  v_mfma_f32_16x16x32_bf16 v[44:47], a[216:219], v[116:119], v[44:47]
  s_mul_i32 s60, s64, 20480
  v_and_b32 v18, 1, v5
  v_lshlrev_b32 v18, 1, v18
  v_mfma_f32_16x16x32_bf16 v[48:51], a[220:223], v[116:119], v[48:51]
  v_lshrrev_b32 v17, 1, v5
  v_or_b32 v18, v18, v17
  v_mfma_f32_16x16x32_bf16 v[32:35], a[224:227], v[120:123], v[32:35]
  v_mul_u32_u24 v16, 1280, v4
  v_lshl_add_u32 v19, v5, 3, v16
  v_lshl_add_u32 v18, v18, 4, v16
  v_mfma_f32_16x16x32_bf16 v[36:39], a[228:231], v[120:123], v[36:39]
  s_lshl_b32 s61, s66, 1
  s_add_u32 s61, s61, s60
  v_mfma_f32_16x16x32_bf16 v[40:43], a[232:235], v[120:123], v[40:43]
  s_lshl_b32 s62, s67, 1
  s_add_u32 s62, s62, s60
  v_add_u32 v17, s77, v2
  v_mfma_f32_16x16x32_bf16 v[44:47], a[236:239], v[120:123], v[44:47]
  v_mfma_f32_16x16x32_bf16 v[48:51], a[240:243], v[120:123], v[48:51]
  buffer_load_dwordx4 v[88:91], v111, s[8:11], s69 offen offset:2048 sc1
  v_mfma_f32_16x16x32_bf16 v[32:35], a[244:247], v[124:127], v[32:35]
  v_mfma_f32_16x16x32_bf16 v[36:39], a[248:251], v[124:127], v[36:39]
  buffer_load_dwordx4 v[92:95], v111, s[8:11], s69 offen offset:3072 sc1
  v_mfma_f32_16x16x32_bf16 v[40:43], a[252:255], v[124:127], v[40:43]
  s_waitcnt vmcnt(8)
  v_max3_u32 v0, v128, v131, 0
  v_mfma_f32_16x16x32_bf16 v[44:47], v[216:219], v[124:127], v[44:47]
  v_max3_u32 v0, v132, v135, v0
  v_max3_u32 v0, v136, v139, v0
  v_max3_u32 v0, v140, v143, v0
  v_mfma_f32_16x16x32_bf16 v[48:51], v[220:223], v[124:127], v[48:51]
  v_cmp_eq_u32 vcc, -1, v0
  s_cbranch_vccnz Lretry43
Lresume44:
  v_mfma_f32_16x16x32_bf16 v[52:55], a[148:151], v[128:131], 0
  v_mfma_f32_16x16x32_bf16 v[56:59], a[152:155], v[128:131], 0
  v_mfma_f32_16x16x32_bf16 v[60:63], a[156:159], v[128:131], 0
  v_mfma_f32_16x16x32_bf16 v[64:67], a[160:163], v[128:131], 0
  v_mfma_f32_16x16x32_bf16 v[68:71], a[164:167], v[128:131], 0
  v_mfma_f32_16x16x32_bf16 v[52:55], a[168:171], v[132:135], v[52:55]
  v_add_u32 v16, s76, v2
  v_mfma_f32_16x16x32_bf16 v[56:59], a[172:175], v[132:135], v[56:59]
  ds_write_b128 v16, v[32:35] offset:0
  v_mfma_f32_16x16x32_bf16 v[60:63], a[176:179], v[132:135], v[60:63]
  ds_write_b128 v16, v[36:39] offset:1024
  v_mfma_f32_16x16x32_bf16 v[64:67], a[180:183], v[132:135], v[64:67]
  v_mfma_f32_16x16x32_bf16 v[68:71], a[184:187], v[132:135], v[68:71]
  ds_write_b128 v16, v[40:43] offset:2048
  v_mfma_f32_16x16x32_bf16 v[52:55], a[188:191], v[136:139], v[52:55]
  ds_write_b128 v16, v[44:47] offset:3072
  v_mfma_f32_16x16x32_bf16 v[56:59], a[192:195], v[136:139], v[56:59]
  ds_write_b128 v16, v[48:51] offset:4096
  v_mfma_f32_16x16x32_bf16 v[60:63], a[196:199], v[136:139], v[60:63]
  s_waitcnt vmcnt(4)
  v_mfma_f32_16x16x32_bf16 v[64:67], a[96:99], v[136:139], v[64:67]
  v_max3_u32 v0, v144, v147, 0
  v_mfma_f32_16x16x32_bf16 v[68:71], v[152:155], v[136:139], v[68:71]
  v_max3_u32 v0, v148, v151, v0
  v_mfma_f32_16x16x32_bf16 v[52:55], v[156:159], v[140:143], v[52:55]
  v_max3_u32 v0, v72, v75, v0
  v_mfma_f32_16x16x32_bf16 v[56:59], v[160:163], v[140:143], v[56:59]
  v_mfma_f32_16x16x32_bf16 v[60:63], v[164:167], v[140:143], v[60:63]
  v_max3_u32 v0, v76, v79, v0
  v_mfma_f32_16x16x32_bf16 v[64:67], v[168:171], v[140:143], v[64:67]
  v_cmp_eq_u32 vcc, -1, v0
  v_mfma_f32_16x16x32_bf16 v[68:71], v[172:175], v[140:143], v[68:71]
  s_cbranch_vccnz Lretry45
Lresume46:
  v_mfma_f32_16x16x32_bf16 v[52:55], v[176:179], v[144:147], v[52:55]
  s_waitcnt vmcnt(0)
  v_max3_u32 v0, v80, v83, 0
  v_mfma_f32_16x16x32_bf16 v[56:59], v[180:183], v[144:147], v[56:59]
  v_max3_u32 v0, v84, v87, v0
  v_max3_u32 v0, v88, v91, v0
  v_mfma_f32_16x16x32_bf16 v[60:63], v[184:187], v[144:147], v[60:63]
  v_max3_u32 v0, v92, v95, v0
  v_cmp_eq_u32 vcc, -1, v0
  s_cbranch_vccnz Lretry47
Lresume48:
  v_mfma_f32_16x16x32_bf16 v[64:67], v[188:191], v[144:147], v[64:67]
  s_waitcnt lgkmcnt(0)
  s_barrier
  v_mfma_f32_16x16x32_bf16 v[68:71], v[224:227], v[144:147], v[68:71]
  ds_read_b128 v[32:35], v17 offset:0
  ds_read_b128 v[36:39], v17 offset:1024
  v_mfma_f32_16x16x32_bf16 v[52:55], v[228:231], v[148:151], v[52:55]
  ds_read_b128 v[40:43], v17 offset:2048
  ds_read_b128 v[44:47], v17 offset:3072
  v_mfma_f32_16x16x32_bf16 v[56:59], v[232:235], v[148:151], v[56:59]
  ds_read_b128 v[48:51], v17 offset:4096
  ds_read_b128 v[112:115], v17 offset:5120
  v_mfma_f32_16x16x32_bf16 v[60:63], v[236:239], v[148:151], v[60:63]
  ds_read_b128 v[116:119], v17 offset:6144
  ds_read_b128 v[120:123], v17 offset:7168
  v_mfma_f32_16x16x32_bf16 v[64:67], v[240:243], v[148:151], v[64:67]
  ds_read_b128 v[124:127], v17 offset:8192
  ds_read_b128 v[128:131], v17 offset:9216
  ds_read_b128 v[132:135], v17 offset:10240
  v_mfma_f32_16x16x32_bf16 v[68:71], v[244:247], v[148:151], v[68:71]
  ds_read_b128 v[136:139], v17 offset:11264
  ds_read_b128 v[140:143], v17 offset:12288
  v_mfma_f32_16x16x32_bf16 v[52:55], v[248:251], v[72:75], v[52:55]
  ds_read_b128 v[96:99], v17 offset:13312
  ds_read_b128 v[100:103], v17 offset:14336
  v_mfma_f32_16x16x32_bf16 v[56:59], v[252:255], v[72:75], v[56:59]
  s_waitcnt lgkmcnt(10)
  v_add_f32 v192, v192, v32
  v_mfma_f32_16x16x32_bf16 v[60:63], a[0:3], v[72:75], v[60:63]
  v_add_f32 v193, v193, v33
  v_add_f32 v194, v194, v34
  v_mfma_f32_16x16x32_bf16 v[64:67], a[4:7], v[72:75], v[64:67]
  v_add_f32 v195, v195, v35
  v_add_f32 v196, v196, v36
  v_mfma_f32_16x16x32_bf16 v[68:71], a[8:11], v[72:75], v[68:71]
  v_add_f32 v197, v197, v37
  v_add_f32 v198, v198, v38
  v_add_f32 v199, v199, v39
  v_mfma_f32_16x16x32_bf16 v[52:55], a[12:15], v[76:79], v[52:55]
  v_add_f32 v200, v200, v40
  v_add_f32 v201, v201, v41
  v_mfma_f32_16x16x32_bf16 v[56:59], a[16:19], v[76:79], v[56:59]
  v_add_f32 v202, v202, v42
  v_add_f32 v203, v203, v43
  v_mfma_f32_16x16x32_bf16 v[60:63], a[20:23], v[76:79], v[60:63]
  v_add_f32 v204, v204, v44
  v_add_f32 v205, v205, v45
  v_mfma_f32_16x16x32_bf16 v[64:67], a[24:27], v[76:79], v[64:67]
  v_add_f32 v206, v206, v46
  v_add_f32 v207, v207, v47
  v_mfma_f32_16x16x32_bf16 v[68:71], a[28:31], v[76:79], v[68:71]
  v_add_f32 v208, v208, v48
  v_add_f32 v209, v209, v49
  v_add_f32 v210, v210, v50
  v_mfma_f32_16x16x32_bf16 v[52:55], a[32:35], v[80:83], v[52:55]
  v_add_f32 v211, v211, v51
  s_waitcnt lgkmcnt(5)
  v_mfma_f32_16x16x32_bf16 v[56:59], a[36:39], v[80:83], v[56:59]
  v_add_f32 v192, v192, v112
  v_add_f32 v193, v193, v113
  v_mfma_f32_16x16x32_bf16 v[60:63], a[40:43], v[80:83], v[60:63]
  v_add_f32 v194, v194, v114
  v_add_f32 v195, v195, v115
  v_mfma_f32_16x16x32_bf16 v[64:67], a[44:47], v[80:83], v[64:67]
  v_add_f32 v196, v196, v116
  v_add_f32 v197, v197, v117
  v_mfma_f32_16x16x32_bf16 v[68:71], a[200:203], v[80:83], v[68:71]
  v_add_f32 v198, v198, v118
  v_add_f32 v199, v199, v119
  v_mfma_f32_16x16x32_bf16 v[52:55], a[204:207], v[84:87], v[52:55]
  v_add_f32 v200, v200, v120
  v_add_f32 v201, v201, v121
  v_add_f32 v202, v202, v122
  v_mfma_f32_16x16x32_bf16 v[56:59], a[208:211], v[84:87], v[56:59]
  v_add_f32 v203, v203, v123
  v_add_f32 v204, v204, v124
  v_mfma_f32_16x16x32_bf16 v[60:63], a[212:215], v[84:87], v[60:63]
  v_add_f32 v205, v205, v125
  v_add_f32 v206, v206, v126
  v_mfma_f32_16x16x32_bf16 v[64:67], a[216:219], v[84:87], v[64:67]
  v_add_f32 v207, v207, v127
  v_add_f32 v208, v208, v128
  v_mfma_f32_16x16x32_bf16 v[68:71], a[220:223], v[84:87], v[68:71]
  v_add_f32 v209, v209, v129
  v_add_f32 v210, v210, v130
  v_mfma_f32_16x16x32_bf16 v[52:55], a[224:227], v[88:91], v[52:55]
  v_add_f32 v211, v211, v131
  s_waitcnt lgkmcnt(0)
  v_mfma_f32_16x16x32_bf16 v[56:59], a[228:231], v[88:91], v[56:59]
  v_add_f32 v192, v192, v132
  v_add_f32 v193, v193, v133
  v_add_f32 v194, v194, v134
  v_mfma_f32_16x16x32_bf16 v[60:63], a[232:235], v[88:91], v[60:63]
  v_add_f32 v195, v195, v135
  v_add_f32 v196, v196, v136
  v_mfma_f32_16x16x32_bf16 v[64:67], a[236:239], v[88:91], v[64:67]
  v_add_f32 v197, v197, v137
  v_add_f32 v198, v198, v138
  v_mfma_f32_16x16x32_bf16 v[68:71], a[240:243], v[88:91], v[68:71]
  v_add_f32 v199, v199, v139
  v_add_f32 v200, v200, v140
  v_mfma_f32_16x16x32_bf16 v[52:55], a[244:247], v[92:95], v[52:55]
  v_add_f32 v201, v201, v141
  v_add_f32 v202, v202, v142
  v_mfma_f32_16x16x32_bf16 v[56:59], a[248:251], v[92:95], v[56:59]
  v_add_f32 v203, v203, v143
  v_add_f32 v204, v204, v96
  v_mfma_f32_16x16x32_bf16 v[60:63], a[252:255], v[92:95], v[60:63]
  v_add_f32 v205, v205, v97
  v_add_f32 v206, v206, v98
  v_add_f32 v207, v207, v99
  v_mfma_f32_16x16x32_bf16 v[64:67], v[216:219], v[92:95], v[64:67]
  v_add_f32 v208, v208, v100
  v_add_f32 v209, v209, v101
  v_mfma_f32_16x16x32_bf16 v[68:71], v[220:223], v[92:95], v[68:71]
  v_add_f32 v210, v210, v102
  v_add_f32 v211, v211, v103
  v_pk_add_f32 v[52:53], v[52:53], v[192:193]
  v_pk_add_f32 v[54:55], v[54:55], v[194:195]
  v_pk_add_f32 v[56:57], v[56:57], v[196:197]
  v_pk_add_f32 v[58:59], v[58:59], v[198:199]
  v_pk_add_f32 v[60:61], v[60:61], v[200:201]
  v_pk_add_f32 v[62:63], v[62:63], v[202:203]
  v_pk_add_f32 v[64:65], v[64:65], v[204:205]
  v_pk_add_f32 v[66:67], v[66:67], v[206:207]
  v_pk_add_f32 v[68:69], v[68:69], v[208:209]
  v_pk_add_f32 v[70:71], v[70:71], v[210:211]
  v_cvt_pk_bf16_f32 v76, v52, v53
  v_cvt_pk_bf16_f32 v77, v54, v55
  v_cvt_pk_bf16_f32 v78, v56, v57
  v_cvt_pk_bf16_f32 v79, v58, v59
  v_cvt_pk_bf16_f32 v80, v60, v61
  v_cvt_pk_bf16_f32 v81, v62, v63
  v_cvt_pk_bf16_f32 v82, v64, v65
  v_cvt_pk_bf16_f32 v83, v66, v67
  v_cvt_pk_bf16_f32 v84, v68, v69
  v_cvt_pk_bf16_f32 v85, v70, v71
  v_permlane16_swap_b32 v76, v78
  v_permlane16_swap_b32 v77, v79
  v_permlane16_swap_b32 v80, v82
  v_permlane16_swap_b32 v81, v83
  buffer_store_dwordx2 v[84:85], v19, s[16:19], s62 offen
  buffer_store_dwordx4 v[76:79], v18, s[16:19], s61 offen offset:0
  buffer_store_dwordx4 v[80:83], v18, s[16:19], s61 offen offset:64
  s_nop 1
L_end:
  s_endpgm
Lretry8:
  s_nop 7
  s_cmp_eq_u32 s78, 0
  s_cbranch_scc1 Lresume9
  s_sub_u32 s78, s78, 1
  buffer_load_dword v109, v108, s[8:11], 0 offen sc1
  s_waitcnt vmcnt(0)
  s_add_u32 s53, s44, 3
  v_subrev_u32 v109, s53, v109
  v_cmp_lt_u32 vcc, 7, v109
  s_nop 4
  s_cbranch_vccnz Lretry8
  s_branch Lresume9
Lretry11:
  s_nop 7
  s_cmp_eq_u32 s78, 0
  s_cbranch_scc1 Lresume12
  s_sub_u32 s78, s78, 1
  buffer_load_dword v0, off, s[40:43], 0 offset:128 sc1
  s_waitcnt vmcnt(0)
  v_cmp_gt_u32 vcc, 96, v0
  s_nop 4
  s_cbranch_vccnz Lretry11
  s_branch Lresume12
Lretry13:
  s_nop 7
  s_cmp_eq_u32 s78, 0
  s_cbranch_scc1 Lresume14
  s_sub_u32 s78, s78, 1
  buffer_load_dword v109, v108, s[8:11], 0 offen sc1
  s_waitcnt vmcnt(0)
  s_add_u32 s53, s44, 4
  v_subrev_u32 v109, s53, v109
  v_cmp_lt_u32 vcc, 7, v109
  s_nop 4
  s_cbranch_vccnz Lretry13
  s_branch Lresume14
Lretry15:
  s_nop 7
  s_cmp_eq_u32 s78, 0
  s_cbranch_scc1 Lresume16
  s_sub_u32 s78, s78, 1
  buffer_load_dwordx4 v[112:115], v2, s[8:11], s60 offen offset:0 sc1
  buffer_load_dwordx4 v[116:119], v2, s[8:11], s60 offen offset:1024 sc1
  buffer_load_dwordx4 v[120:123], v2, s[8:11], s60 offen offset:2048 sc1
  buffer_load_dwordx4 v[124:127], v2, s[8:11], s60 offen offset:3072 sc1
  buffer_load_dwordx4 v[128:131], v17, s[8:11], s60 offen offset:2048 sc1
  s_waitcnt vmcnt(0)
  v_max3_u32 v0, v112, v115, 0
  v_max3_u32 v0, v116, v119, v0
  v_max3_u32 v0, v120, v123, v0
  v_max3_u32 v0, v124, v127, v0
  v_max3_u32 v0, v128, v131, v0
  v_cmp_eq_u32 vcc, -1, v0
  s_nop 4
  s_cbranch_vccnz Lretry15
  ds_write_b128 v212, v[112:115] offset:0
  ds_write_b128 v212, v[116:119] offset:1024
  ds_write_b128 v212, v[120:123] offset:2048
  ds_write_b128 v212, v[124:127] offset:3072
  ds_write_b128 v212, v[128:131] offset:4096
  s_waitcnt lgkmcnt(0)
  s_branch Lresume16
Lretry17:
  s_nop 7
  s_cmp_eq_u32 s78, 0
  s_cbranch_scc1 Lresume18
  s_sub_u32 s78, s78, 1
  buffer_load_dwordx4 v[132:135], v2, s[8:11], s61 offen offset:0 sc1
  buffer_load_dwordx4 v[136:139], v2, s[8:11], s61 offen offset:1024 sc1
  buffer_load_dwordx4 v[140:143], v2, s[8:11], s61 offen offset:2048 sc1
  buffer_load_dwordx4 v[144:147], v2, s[8:11], s61 offen offset:3072 sc1
  buffer_load_dwordx4 v[148:151], v17, s[8:11], s61 offen offset:2048 sc1
  s_waitcnt vmcnt(0)
  v_max3_u32 v0, v132, v135, 0
  v_max3_u32 v0, v136, v139, v0
  v_max3_u32 v0, v140, v143, v0
  v_max3_u32 v0, v144, v147, v0
  v_max3_u32 v0, v148, v151, v0
  v_cmp_eq_u32 vcc, -1, v0
  s_nop 4
  s_cbranch_vccnz Lretry17
  ds_write_b128 v213, v[132:135] offset:0
  ds_write_b128 v213, v[136:139] offset:1024
  ds_write_b128 v213, v[140:143] offset:2048
  ds_write_b128 v213, v[144:147] offset:3072
  ds_write_b128 v213, v[148:151] offset:4096
  s_waitcnt lgkmcnt(0)
  s_branch Lresume18
Lretry19:
  s_nop 7
  s_cmp_eq_u32 s78, 0
  s_cbranch_scc1 Lresume20
  s_sub_u32 s78, s78, 1
  buffer_load_dwordx2 v[76:77], v16, s[8:11], s74 offen sc1
  buffer_load_dwordx2 v[78:79], v16, s[8:11], s74 offen offset:128 sc1
  s_waitcnt vmcnt(0)
  v_max3_u32 v0, v76, v78, 0
  v_cmp_eq_u32 vcc, -1, v0
  s_nop 4
  s_cbranch_vccnz Lretry19
  s_branch Lresume20
Lretry21:
  s_nop 7
  s_cmp_eq_u32 s78, 0
  s_cbranch_scc1 Lresume22
  s_sub_u32 s78, s78, 1
  buffer_load_dwordx4 v[152:155], v2, s[8:11], s62 offen offset:0 sc1
  buffer_load_dwordx4 v[156:159], v2, s[8:11], s62 offen offset:1024 sc1
  buffer_load_dwordx4 v[160:163], v2, s[8:11], s62 offen offset:2048 sc1
  buffer_load_dwordx4 v[164:167], v2, s[8:11], s62 offen offset:3072 sc1
  buffer_load_dwordx4 v[168:171], v17, s[8:11], s62 offen offset:2048 sc1
  s_waitcnt vmcnt(0)
  v_max3_u32 v0, v152, v155, 0
  v_max3_u32 v0, v156, v159, v0
  v_max3_u32 v0, v160, v163, v0
  v_max3_u32 v0, v164, v167, v0
  v_max3_u32 v0, v168, v171, v0
  v_cmp_eq_u32 vcc, -1, v0
  s_nop 4
  s_cbranch_vccnz Lretry21
  ds_write_b128 v214, v[152:155] offset:0
  ds_write_b128 v214, v[156:159] offset:1024
  ds_write_b128 v214, v[160:163] offset:2048
  ds_write_b128 v214, v[164:167] offset:3072
  ds_write_b128 v214, v[168:171] offset:4096
  s_waitcnt lgkmcnt(0)
  s_branch Lresume22
Lretry23:
  s_nop 7
  s_cmp_eq_u32 s78, 0
  s_cbranch_scc1 Lresume24
  s_sub_u32 s78, s78, 1
  buffer_load_dwordx4 v[172:175], v2, s[8:11], s63 offen offset:0 sc1
  buffer_load_dwordx4 v[176:179], v2, s[8:11], s63 offen offset:1024 sc1
  buffer_load_dwordx4 v[180:183], v2, s[8:11], s63 offen offset:2048 sc1
  buffer_load_dwordx4 v[184:187], v2, s[8:11], s63 offen offset:3072 sc1
  buffer_load_dwordx4 v[188:191], v17, s[8:11], s63 offen offset:2048 sc1
  s_waitcnt vmcnt(0)
  v_max3_u32 v0, v172, v175, 0
  v_max3_u32 v0, v176, v179, v0
  v_max3_u32 v0, v180, v183, v0
  v_max3_u32 v0, v184, v187, v0
  v_max3_u32 v0, v188, v191, v0
  v_cmp_eq_u32 vcc, -1, v0
  s_nop 4
  s_cbranch_vccnz Lretry23
  ds_write_b128 v215, v[172:175] offset:0
  ds_write_b128 v215, v[176:179] offset:1024
  ds_write_b128 v215, v[180:183] offset:2048
  ds_write_b128 v215, v[184:187] offset:3072
  ds_write_b128 v215, v[188:191] offset:4096
  s_waitcnt lgkmcnt(0)
  s_branch Lresume24
Lretry25:
  s_nop 7
  s_cmp_eq_u32 s78, 0
  s_cbranch_scc1 Lresume26
  s_sub_u32 s78, s78, 1
  buffer_load_dwordx4 v[112:115], v108, s[8:11], s63 offen offset:0 sc1
  buffer_load_dwordx4 v[116:119], v108, s[8:11], s63 offen offset:1024 sc1
  buffer_load_dwordx4 v[120:123], v108, s[8:11], s63 offen offset:2048 sc1
  buffer_load_dwordx4 v[124:127], v108, s[8:11], s63 offen offset:3072 sc1
  buffer_load_dwordx4 v[128:131], v108, s[8:11], s68 offen offset:0 sc1
  buffer_load_dwordx4 v[132:135], v108, s[8:11], s68 offen offset:1024 sc1
  buffer_load_dwordx4 v[136:139], v108, s[8:11], s68 offen offset:2048 sc1
  buffer_load_dwordx4 v[140:143], v108, s[8:11], s68 offen offset:3072 sc1
  s_waitcnt vmcnt(0)
  v_max3_u32 v0, v112, v115, 0
  v_max3_u32 v0, v116, v119, v0
  v_max3_u32 v0, v120, v123, v0
  v_max3_u32 v0, v124, v127, v0
  v_cmp_eq_u32 vcc, -1, v0
  s_nop 4
  s_cbranch_vccnz Lretry25
  s_branch Lresume26
Lretry27:
  s_nop 7
  s_cmp_eq_u32 s78, 0
  s_cbranch_scc1 Lresume28
  s_sub_u32 s78, s78, 1
  buffer_load_dwordx4 v[128:131], v108, s[8:11], s68 offen offset:0 sc1
  buffer_load_dwordx4 v[132:135], v108, s[8:11], s68 offen offset:1024 sc1
  buffer_load_dwordx4 v[136:139], v108, s[8:11], s68 offen offset:2048 sc1
  buffer_load_dwordx4 v[140:143], v108, s[8:11], s68 offen offset:3072 sc1
  s_waitcnt vmcnt(0)
  v_max3_u32 v0, v128, v131, 0
  v_max3_u32 v0, v132, v135, v0
  v_max3_u32 v0, v136, v139, v0
  v_max3_u32 v0, v140, v143, v0
  v_cmp_eq_u32 vcc, -1, v0
  s_nop 4
  s_cbranch_vccnz Lretry27
  s_branch Lresume28
Lretry29:
  s_nop 7
  s_cmp_eq_u32 s78, 0
  s_cbranch_scc1 Lresume30
  s_sub_u32 s78, s78, 1
  buffer_load_dwordx4 v[144:147], v108, s[8:11], s69 offen offset:0 sc1
  buffer_load_dwordx4 v[148:151], v108, s[8:11], s69 offen offset:1024 sc1
  buffer_load_dwordx4 v[72:75], v108, s[8:11], s69 offen offset:2048 sc1
  buffer_load_dwordx4 v[76:79], v108, s[8:11], s69 offen offset:3072 sc1
  s_waitcnt vmcnt(0)
  v_max3_u32 v0, v144, v147, 0
  v_max3_u32 v0, v148, v151, v0
  v_max3_u32 v0, v72, v75, v0
  v_max3_u32 v0, v76, v79, v0
  v_cmp_eq_u32 vcc, -1, v0
  s_nop 4
  s_cbranch_vccnz Lretry29
  s_branch Lresume30
Lretry31:
  s_nop 7
  s_cmp_eq_u32 s78, 0
  s_cbranch_scc1 Lresume32
  s_sub_u32 s78, s78, 1
  buffer_load_dwordx4 v[80:83], v109, s[8:11], s63 offen offset:0 sc1
  buffer_load_dwordx4 v[84:87], v109, s[8:11], s63 offen offset:1024 sc1
  buffer_load_dwordx4 v[88:91], v109, s[8:11], s63 offen offset:2048 sc1
  buffer_load_dwordx4 v[92:95], v109, s[8:11], s63 offen offset:3072 sc1
  s_waitcnt vmcnt(0)
  v_max3_u32 v0, v80, v83, 0
  v_max3_u32 v0, v84, v87, v0
  v_max3_u32 v0, v88, v91, v0
  v_max3_u32 v0, v92, v95, v0
  v_cmp_eq_u32 vcc, -1, v0
  s_nop 4
  s_cbranch_vccnz Lretry31
  s_branch Lresume32
Lretry33:
  s_nop 7
  s_cmp_eq_u32 s78, 0
  s_cbranch_scc1 Lresume34
  s_sub_u32 s78, s78, 1
  buffer_load_dwordx4 v[112:115], v109, s[8:11], s68 offen offset:0 sc1
  buffer_load_dwordx4 v[116:119], v109, s[8:11], s68 offen offset:1024 sc1
  buffer_load_dwordx4 v[120:123], v109, s[8:11], s68 offen offset:2048 sc1
  buffer_load_dwordx4 v[124:127], v109, s[8:11], s68 offen offset:3072 sc1
  s_waitcnt vmcnt(0)
  v_max3_u32 v0, v112, v115, 0
  v_max3_u32 v0, v116, v119, v0
  v_max3_u32 v0, v120, v123, v0
  v_max3_u32 v0, v124, v127, v0
  v_cmp_eq_u32 vcc, -1, v0
  s_nop 4
  s_cbranch_vccnz Lretry33
  s_branch Lresume34
Lretry35:
  s_nop 7
  s_cmp_eq_u32 s78, 0
  s_cbranch_scc1 Lresume36
  s_sub_u32 s78, s78, 1
  buffer_load_dwordx4 v[128:131], v109, s[8:11], s69 offen offset:0 sc1
  buffer_load_dwordx4 v[132:135], v109, s[8:11], s69 offen offset:1024 sc1
  buffer_load_dwordx4 v[136:139], v109, s[8:11], s69 offen offset:2048 sc1
  buffer_load_dwordx4 v[140:143], v109, s[8:11], s69 offen offset:3072 sc1
  s_waitcnt vmcnt(0)
  v_max3_u32 v0, v128, v131, 0
  v_max3_u32 v0, v132, v135, v0
  v_max3_u32 v0, v136, v139, v0
  v_max3_u32 v0, v140, v143, v0
  v_cmp_eq_u32 vcc, -1, v0
  s_nop 4
  s_cbranch_vccnz Lretry35
  s_branch Lresume36
Lretry37:
  s_nop 7
  s_cmp_eq_u32 s78, 0
  s_cbranch_scc1 Lresume38
  s_sub_u32 s78, s78, 1
  buffer_load_dwordx4 v[144:147], v110, s[8:11], s63 offen offset:0 sc1
  buffer_load_dwordx4 v[148:151], v110, s[8:11], s63 offen offset:1024 sc1
  buffer_load_dwordx4 v[72:75], v110, s[8:11], s63 offen offset:2048 sc1
  buffer_load_dwordx4 v[76:79], v110, s[8:11], s63 offen offset:3072 sc1
  s_waitcnt vmcnt(0)
  v_max3_u32 v0, v144, v147, 0
  v_max3_u32 v0, v148, v151, v0
  v_max3_u32 v0, v72, v75, v0
  v_max3_u32 v0, v76, v79, v0
  v_cmp_eq_u32 vcc, -1, v0
  s_nop 4
  s_cbranch_vccnz Lretry37
  s_branch Lresume38
Lretry39:
  s_nop 7
  s_cmp_eq_u32 s78, 0
  s_cbranch_scc1 Lresume40
  s_sub_u32 s78, s78, 1
  buffer_load_dwordx4 v[80:83], v110, s[8:11], s68 offen offset:0 sc1
  buffer_load_dwordx4 v[84:87], v110, s[8:11], s68 offen offset:1024 sc1
  buffer_load_dwordx4 v[88:91], v110, s[8:11], s68 offen offset:2048 sc1
  buffer_load_dwordx4 v[92:95], v110, s[8:11], s68 offen offset:3072 sc1
  s_waitcnt vmcnt(0)
  v_max3_u32 v0, v80, v83, 0
  v_max3_u32 v0, v84, v87, v0
  v_max3_u32 v0, v88, v91, v0
  v_max3_u32 v0, v92, v95, v0
  v_cmp_eq_u32 vcc, -1, v0
  s_nop 4
  s_cbranch_vccnz Lretry39
  s_branch Lresume40
Lretry41:
  s_nop 7
  s_cmp_eq_u32 s78, 0
  s_cbranch_scc1 Lresume42
  s_sub_u32 s78, s78, 1
  buffer_load_dwordx4 v[112:115], v110, s[8:11], s69 offen offset:0 sc1
  buffer_load_dwordx4 v[116:119], v110, s[8:11], s69 offen offset:1024 sc1
  buffer_load_dwordx4 v[120:123], v110, s[8:11], s69 offen offset:2048 sc1
  buffer_load_dwordx4 v[124:127], v110, s[8:11], s69 offen offset:3072 sc1
  s_waitcnt vmcnt(0)
  v_max3_u32 v0, v112, v115, 0
  v_max3_u32 v0, v116, v119, v0
  v_max3_u32 v0, v120, v123, v0
  v_max3_u32 v0, v124, v127, v0
  v_cmp_eq_u32 vcc, -1, v0
  s_nop 4
  s_cbranch_vccnz Lretry41
  s_branch Lresume42
Lretry43:
  s_nop 7
  s_cmp_eq_u32 s78, 0
  s_cbranch_scc1 Lresume44
  s_sub_u32 s78, s78, 1
  buffer_load_dwordx4 v[128:131], v111, s[8:11], s63 offen offset:0 sc1
  buffer_load_dwordx4 v[132:135], v111, s[8:11], s63 offen offset:1024 sc1
  buffer_load_dwordx4 v[136:139], v111, s[8:11], s63 offen offset:2048 sc1
  buffer_load_dwordx4 v[140:143], v111, s[8:11], s63 offen offset:3072 sc1
  s_waitcnt vmcnt(0)
  v_max3_u32 v0, v128, v131, 0
  v_max3_u32 v0, v132, v135, v0
  v_max3_u32 v0, v136, v139, v0
  v_max3_u32 v0, v140, v143, v0
  v_cmp_eq_u32 vcc, -1, v0
  s_nop 4
  s_cbranch_vccnz Lretry43
  s_branch Lresume44
Lretry45:
  s_nop 7
  s_cmp_eq_u32 s78, 0
  s_cbranch_scc1 Lresume46
  s_sub_u32 s78, s78, 1
  buffer_load_dwordx4 v[144:147], v111, s[8:11], s68 offen offset:0 sc1
  buffer_load_dwordx4 v[148:151], v111, s[8:11], s68 offen offset:1024 sc1
  buffer_load_dwordx4 v[72:75], v111, s[8:11], s68 offen offset:2048 sc1
  buffer_load_dwordx4 v[76:79], v111, s[8:11], s68 offen offset:3072 sc1
  s_waitcnt vmcnt(0)
  v_max3_u32 v0, v144, v147, 0
  v_max3_u32 v0, v148, v151, v0
  v_max3_u32 v0, v72, v75, v0
  v_max3_u32 v0, v76, v79, v0
  v_cmp_eq_u32 vcc, -1, v0
  s_nop 4
  s_cbranch_vccnz Lretry45
  s_branch Lresume46
Lretry47:
  s_nop 7
  s_cmp_eq_u32 s78, 0
  s_cbranch_scc1 Lresume48
  s_sub_u32 s78, s78, 1
  buffer_load_dwordx4 v[80:83], v111, s[8:11], s69 offen offset:0 sc1
  buffer_load_dwordx4 v[84:87], v111, s[8:11], s69 offen offset:1024 sc1
  buffer_load_dwordx4 v[88:91], v111, s[8:11], s69 offen offset:2048 sc1
  buffer_load_dwordx4 v[92:95], v111, s[8:11], s69 offen offset:3072 sc1
  s_waitcnt vmcnt(0)
  v_max3_u32 v0, v80, v83, 0
  v_max3_u32 v0, v84, v87, v0
  v_max3_u32 v0, v88, v91, v0
  v_max3_u32 v0, v92, v95, v0
  v_cmp_eq_u32 vcc, -1, v0
  s_nop 4
  s_cbranch_vccnz Lretry47
  s_branch Lresume48
code_end:
.section .rodata,"a"
.p2align 6
.amdhsa_kernel sequential_preLN__spectral_gfnet__mixer_s_mlp__prompt_kernel
  .amdhsa_next_free_vgpr 512
  .amdhsa_next_free_sgpr 102
  .amdhsa_accum_offset 256
  .amdhsa_group_segment_fixed_size 0
  .amdhsa_kernarg_size 88
  .amdhsa_user_sgpr_count 2
  .amdhsa_user_sgpr_kernarg_segment_ptr 1
  .amdhsa_system_sgpr_workgroup_id_x 1
.end_amdhsa_kernel
```
